```python
import torch

def _softmax(x, axis=-1):
    return torch.softmax(x, dim=axis)
def _gelu(x):
    return torch.nn.functional.gelu(x, approximate="tanh")
def _silu(x):
    return torch.nn.functional.silu(x)
def _sigmoid(x):
    return torch.sigmoid(x)
def _layernorm(x, axis=-1, eps=1e-5):
    m = x.mean(dim=axis, keepdim=True)
    v = x.var(dim=axis, keepdim=True, unbiased=False)
    return (x - m) / torch.sqrt(v + eps)
def _scatter_add(tgt, idx, src, axis=0):
    return tgt.clone().index_add_(axis, idx, src)
def _segment_sum(src, seg, n):
    out = torch.zeros((n,) + src.shape[1:], dtype=src.dtype)
    return out.index_add_(0, seg, src)
def _pad(x, pw):
    flat = tuple(v for pair in reversed(pw) for v in pair)
    return torch.nn.functional.pad(x, flat)

kernel_name = 'gated_mix__mha_block_cached__glu_gated_bilinear__decode'

def setup_inputs():

    _w = (lambda a: (lambda t: t.to(torch.bfloat16) if t.is_floating_point() else t)(torch.as_tensor(a)))
    def _A_setup():
        B, Sq, D = 4, 1, 640
        H, Sk, Dh = 32, 4096, 128
        return {
            "x": _w((lambda *s: torch.randn(*s, dtype=torch.bfloat16) * 0.05)(B, Sq, D)),
            "k_cache": _w((lambda *s: torch.randn(*s, dtype=torch.bfloat16) * 6.4)(B, H, Sk, Dh)),
            "v_cache": _w((lambda *s: torch.randn(*s, dtype=torch.bfloat16) * 0.05)(B, H, Sk, Dh)),
            "wq": _w((lambda *s: torch.randn(*s, dtype=torch.bfloat16) * 6.4)(D, H * Dh) * (D ** -0.5)),
            "wo": _w((lambda *s: torch.randn(*s, dtype=torch.bfloat16) * 0.05)(H * Dh, D) * ((H * Dh) ** -0.5)),
        }
    _A_in = _A_setup()

    def _B_setup():
        B, S, D, F = 4, 1, 640, 1728
        return {
            "x": _w((lambda *s: torch.randn(*s, dtype=torch.bfloat16) * 0.05)(B, S, D)),
            "w_gate": _w((lambda *s: torch.randn(*s, dtype=torch.bfloat16) * 0.4)(D, F) * (D ** -0.5)),
            "w_up": _w((lambda *s: torch.randn(*s, dtype=torch.bfloat16) * 0.4)(D, F) * (D ** -0.5)),
            "w_down": _w((lambda *s: torch.randn(*s, dtype=torch.bfloat16) * 0.4)(F, D) * (F ** -0.5)),
        }
    _B_in = _B_setup()

    return {
        "A_x": _A_in["x"],
        "A_k_cache": _A_in["k_cache"],
        "A_v_cache": _A_in["v_cache"],
        "A_wq": _A_in["wq"],
        "A_wo": _A_in["wo"],
        "B_x": _B_in["x"],
        "B_w_gate": _B_in["w_gate"],
        "B_w_up": _B_in["w_up"],
        "B_w_down": _B_in["w_down"],
        "gate_w": _w((lambda *s: torch.randn(*s, dtype=torch.bfloat16) * 0.05)(640) * 16.0),
    }

def reference(A_x, A_k_cache, A_v_cache, A_wq, A_wo, B_x, B_w_gate, B_w_up, B_w_down, gate_w):
    def _A_ref(x, k_cache, v_cache, wq, wo):
        B, Sq, D = x.shape
        H, Dh = 32, 128
        q = (lambda x, *d: x.permute(*d))((x @ wq).reshape(B, Sq, H, Dh), 0, 2, 1, 3)
        scores = torch.einsum("bhqd,bhkd->bhqk", q, k_cache) * (Dh ** -0.5)
        p = _softmax(scores, axis=-1)
        o = torch.einsum("bhqk,bhkd->bhqd", p, v_cache)
        return (lambda x, *d: x.permute(*d))(o, 0, 2, 1, 3).reshape(B, Sq, H * Dh) @ wo

    def _B_ref(x, w_gate, w_up, w_down):
        g = torch.einsum("bsd,df->bsf", x, w_gate)
        u = torch.einsum("bsd,df->bsf", x, w_up)
        h = g * u
        return torch.einsum("bsf,fd->bsd", h, w_down)

    x = A_x
    g = _sigmoid((x * gate_w).sum(-1, keepdims=True))
    a = _A_ref(x, A_k_cache, A_v_cache, A_wq, A_wo)
    b = _B_ref(x, B_w_gate, B_w_up, B_w_down)
    return g * a + (1 - g) * b
```

```asm
; @launch grid=(256,1,1) block=(512,1,1) lds=145920
.amdgcn_target "amdgcn-amd-amdhsa--gfx950"
.text
.globl gated_mix__mha_block_cached__glu_gated_bilinear__decode_kernel
.p2align 8
.type gated_mix__mha_block_cached__glu_gated_bilinear__decode_kernel,@function
gated_mix__mha_block_cached__glu_gated_bilinear__decode_kernel:
    s_cmp_ge_u32 s2, 256
    s_cbranch_scc1 L_end
    s_load_dwordx16 s[16:31], s[0:1], 0
    s_load_dwordx8 s[32:39], s[0:1], 64
    s_load_dwordx2 s[40:41], s[0:1], 96
    v_lshrrev_b32 v1, 6, v0
    v_and_b32 v0, 63, v0
    s_mov_b32 s72, 0
    v_readfirstlane_b32 s3, v1
    s_and_b32 s4, s2, 7
    s_lshr_b32 s5, s2, 3
    s_and_b32 s6, s5, 3
    s_lshl_b32 s6, s6, 3
    s_add_u32 s6, s6, s4
    s_lshr_b32 s7, s5, 2
    s_and_b32 s7, s7, 3
    s_lshr_b32 s8, s5, 4
    s_lshl_b32 s9, s7, 5
    s_add_u32 s9, s9, s6
    s_cmp_ge_u32 s3, 4
    s_cbranch_scc1 L_helper
    s_lshl_b32 s12, s9, 20
    s_lshl_b32 s13, s8, 16
    s_and_b32 s10, s3, 1
    s_lshl_b32 s10, s10, 12
    s_add_u32 s13, s13, s10
    s_lshr_b32 s10, s3, 1
    s_lshl_b32 s10, s10, 13
    s_add_u32 s13, s13, s10
    s_lshr_b32 s76, s9, 3
    s_xor_b32 s76, s76, s9
    s_bitcmp1_b32 s76, 0
    s_mov_b32 s76, 0xffffb400
    s_cselect_b32 s76, 0xffff3400, s76
    s_mov_b32 s77, 0x13400
    s_cselect_b32 s77, 0x1b400, s77
    s_mov_b32 s78, 0x0
    s_cselect_b32 s78, 0x4000, s78
    v_lshlrev_b32 v1, 4, v0
    v_add_u32 v1, s13, v1
    s_mov_b32 s46, 0x100000
    s_mov_b32 s47, 0x00020000
    s_mov_b32 s10, s78
    s_waitcnt lgkmcnt(0)
    s_add_u32 s44, s18, s12
    s_addc_u32 s45, s19, 0
    s_add_u32 s42, s20, s12
    s_addc_u32 s43, s21, 0
    buffer_load_dwordx4 v[64:67], v1, s[44:47], s10 offen nt
    s_add_u32 s10, s10, 0x400
    buffer_load_dwordx4 v[68:71], v1, s[44:47], s10 offen nt
    s_add_u32 s10, s10, 0x400
    buffer_load_dwordx4 v[72:75], v1, s[44:47], s10 offen nt
    s_add_u32 s10, s10, 0x400
    buffer_load_dwordx4 v[76:79], v1, s[44:47], s10 offen nt
    s_add_u32 s10, s10, 0x7400
    s_barrier
    buffer_load_dwordx4 v[80:83], v1, s[44:47], s10 offen nt
    s_add_u32 s10, s10, 0x400
    buffer_load_dwordx4 v[84:87], v1, s[44:47], s10 offen nt
    s_add_u32 s10, s10, 0x400
    buffer_load_dwordx4 v[88:91], v1, s[44:47], s10 offen nt
    s_add_u32 s10, s10, 0x400
    buffer_load_dwordx4 v[92:95], v1, s[44:47], s10 offen nt
    s_add_u32 s10, s10, s76
    buffer_load_dwordx4 v[96:99], v1, s[44:47], s10 offen nt
    s_add_u32 s10, s10, 0x400
    s_mov_b32 s62, 0x22222222
    s_mov_b32 s63, 0x22222222
    s_mov_b32 s64, 0x44444444
    s_mov_b32 s65, 0x44444444
    s_mov_b32 s66, 0x88888888
    s_mov_b32 s67, 0x88888888
    v_lshrrev_b32 v24, 4, v0
    v_and_b32 v25, 15, v0
    v_lshlrev_b32 v25, 4, v25
    v_mul_u32_u24 v2, 528, v24
    s_mul_i32 s12, s3, 2112
    v_add_u32 v28, s12, v2
    v_and_b32 v26, 3, v0
    v_lshlrev_b32 v26, 4, v26
    v_bfe_u32 v27, v0, 2, 1
    v_lshl_add_u32 v26, v27, 3, v26
    v_bfe_u32 v27, v0, 3, 1
    v_lshl_add_u32 v26, v27, 2, v26
    v_add_u32 v2, v28, v26
    v_mov_b32 v29, v2
    v_mov_b32 v3, 0xff800000
    v_mov_b32 v30, 0
    v_mov_b32 v40, 1
    s_mov_b32 s69, 0
    s_mov_b32 s68, 0
    s_mov_b32 s11, 0
    s_waitcnt vmcnt(8)
    buffer_load_dwordx4 v[100:103], v1, s[44:47], s10 offen nt
    s_add_u32 s10, s10, 0x400
    s_waitcnt vmcnt(8)
    buffer_load_dwordx4 v[104:107], v1, s[44:47], s10 offen nt
    s_add_u32 s10, s10, 0x400
    s_waitcnt vmcnt(8)
    buffer_load_dwordx4 v[108:111], v1, s[44:47], s10 offen nt
    s_add_u32 s10, s10, 0x7400
    s_waitcnt vmcnt(8)
    buffer_load_dwordx4 v[112:115], v1, s[44:47], s10 offen nt
    s_add_u32 s10, s10, 0x400
    s_waitcnt vmcnt(8)
    buffer_load_dwordx4 v[116:119], v1, s[44:47], s10 offen nt
    s_add_u32 s10, s10, 0x400
    s_waitcnt vmcnt(8)
    buffer_load_dwordx4 v[120:123], v1, s[44:47], s10 offen nt
    s_add_u32 s10, s10, 0x400
    s_waitcnt vmcnt(8)
    buffer_load_dwordx4 v[124:127], v1, s[44:47], s10 offen nt
    s_add_u32 s10, s10, s77
    s_waitcnt vmcnt(8)
    buffer_load_dwordx4 v[128:131], v1, s[44:47], s10 offen nt
    s_add_u32 s10, s10, 0x400
    s_waitcnt vmcnt(8)
    buffer_load_dwordx4 v[132:135], v1, s[44:47], s10 offen nt
    s_add_u32 s10, s10, 0x400
    s_waitcnt vmcnt(8)
    buffer_load_dwordx4 v[136:139], v1, s[44:47], s10 offen nt
    s_add_u32 s10, s10, 0x400
    s_waitcnt vmcnt(8)
    buffer_load_dwordx4 v[140:143], v1, s[44:47], s10 offen nt
    s_add_u32 s10, s10, 0x7400
    s_waitcnt vmcnt(8)
    buffer_load_dwordx4 v[144:147], v1, s[44:47], s10 offen nt
    s_add_u32 s10, s10, 0x400
    s_waitcnt vmcnt(8)
    buffer_load_dwordx4 v[148:151], v1, s[44:47], s10 offen nt
    s_add_u32 s10, s10, 0x400
    s_waitcnt vmcnt(8)
    buffer_load_dwordx4 v[152:155], v1, s[44:47], s10 offen nt
    s_add_u32 s10, s10, 0x400
    s_waitcnt vmcnt(8)
    buffer_load_dwordx4 v[156:159], v1, s[44:47], s10 offen nt
    s_add_u32 s10, s10, s76
    s_waitcnt vmcnt(8)
    buffer_load_dwordx4 v[160:163], v1, s[44:47], s10 offen nt
    s_add_u32 s10, s10, 0x400
    s_waitcnt vmcnt(8)
    buffer_load_dwordx4 v[164:167], v1, s[44:47], s10 offen nt
    s_add_u32 s10, s10, 0x400
    s_waitcnt vmcnt(8)
    buffer_load_dwordx4 v[168:171], v1, s[44:47], s10 offen nt
    s_add_u32 s10, s10, 0x400
    s_waitcnt vmcnt(8)
    buffer_load_dwordx4 v[172:175], v1, s[44:47], s10 offen nt
    s_add_u32 s10, s10, 0x7400
    s_waitcnt vmcnt(8)
    buffer_load_dwordx4 v[176:179], v1, s[44:47], s10 offen nt
    s_add_u32 s10, s10, 0x400
    s_waitcnt vmcnt(8)
    buffer_load_dwordx4 v[180:183], v1, s[44:47], s10 offen nt
    s_add_u32 s10, s10, 0x400
    s_waitcnt vmcnt(8)
    buffer_load_dwordx4 v[184:187], v1, s[44:47], s10 offen nt
    s_add_u32 s10, s10, 0x400
    s_waitcnt vmcnt(8)
    buffer_load_dwordx4 v[188:191], v1, s[44:47], s10 offen nt
    s_add_u32 s10, s10, s77
    s_waitcnt vmcnt(8)
    buffer_load_dwordx4 v[192:195], v1, s[44:47], s10 offen nt
    s_add_u32 s10, s10, 0x400
    s_waitcnt vmcnt(8)
    buffer_load_dwordx4 v[196:199], v1, s[44:47], s10 offen nt
    s_add_u32 s10, s10, 0x400
    s_waitcnt vmcnt(8)
    buffer_load_dwordx4 v[200:203], v1, s[44:47], s10 offen nt
    s_add_u32 s10, s10, 0x400
    s_waitcnt vmcnt(8)
    buffer_load_dwordx4 v[204:207], v1, s[44:47], s10 offen nt
    s_add_u32 s10, s10, 0x7400
    s_waitcnt vmcnt(8)
    buffer_load_dwordx4 v[208:211], v1, s[44:47], s10 offen nt
    s_add_u32 s10, s10, 0x400
    s_waitcnt vmcnt(8)
    buffer_load_dwordx4 v[212:215], v1, s[44:47], s10 offen nt
    s_add_u32 s10, s10, 0x400
    s_waitcnt vmcnt(8)
    buffer_load_dwordx4 v[216:219], v1, s[44:47], s10 offen nt
    s_add_u32 s10, s10, 0x400
    s_waitcnt vmcnt(8)
    buffer_load_dwordx4 v[220:223], v1, s[44:47], s10 offen nt
    s_add_u32 s10, s10, s76
    s_waitcnt vmcnt(8)
    buffer_load_dwordx4 v[224:227], v1, s[44:47], s10 offen nt
    s_add_u32 s10, s10, 0x400
    s_waitcnt vmcnt(8)
    buffer_load_dwordx4 v[228:231], v1, s[44:47], s10 offen nt
    s_add_u32 s10, s10, 0x400
    s_waitcnt vmcnt(8)
    buffer_load_dwordx4 v[232:235], v1, s[44:47], s10 offen nt
    s_add_u32 s10, s10, 0x400
    s_waitcnt vmcnt(8)
    buffer_load_dwordx4 v[236:239], v1, s[44:47], s10 offen nt
    s_add_u32 s10, s10, 0x7400
    s_waitcnt vmcnt(8)
    buffer_load_dwordx4 v[240:243], v1, s[44:47], s10 offen nt
    s_add_u32 s10, s10, 0x400
    s_waitcnt vmcnt(8)
    buffer_load_dwordx4 v[244:247], v1, s[44:47], s10 offen nt
    s_add_u32 s10, s10, 0x400
    s_waitcnt vmcnt(8)
    buffer_load_dwordx4 v[248:251], v1, s[44:47], s10 offen nt
    s_add_u32 s10, s10, 0x400
    s_waitcnt vmcnt(8)
    buffer_load_dwordx4 v[252:255], v1, s[44:47], s10 offen nt
    s_add_u32 s10, s10, s77
L_lw1:
    ds_read_b32 v31, v30 offset:10916
    s_waitcnt lgkmcnt(0)
    v_readfirstlane_b32 s12, v31
    s_cmp_ge_u32 s12, 1
    s_cbranch_scc1 L_lw2
    s_add_u32 s72, s72, 1
    s_cmp_gt_u32 s72, 400000
    s_cbranch_scc1 L_lw2
    s_sleep 1
    s_branch L_lw1
L_lw2:
    ds_read_b128 v[4:7], v25 offset:8448
    s_waitcnt lgkmcnt(0)
    s_waitcnt vmcnt(44)
    v_dot2_f32_bf16 v8, v64, v4, 0
    v_dot2_f32_bf16 v9, v68, v4, 0
    v_dot2_f32_bf16 v10, v72, v4, 0
    v_dot2_f32_bf16 v11, v76, v4, 0
    v_dot2_f32_bf16 v8, v65, v5, v8
    v_dot2_f32_bf16 v9, v69, v5, v9
    v_dot2_f32_bf16 v10, v73, v5, v10
    v_dot2_f32_bf16 v11, v77, v5, v11
    v_dot2_f32_bf16 v8, v66, v6, v8
    v_dot2_f32_bf16 v9, v70, v6, v9
    v_dot2_f32_bf16 v10, v74, v6, v10
    v_dot2_f32_bf16 v11, v78, v6, v11
    v_dot2_f32_bf16 v8, v67, v7, v8
    v_dot2_f32_bf16 v9, v71, v7, v9
    v_dot2_f32_bf16 v10, v75, v7, v10
    v_dot2_f32_bf16 v11, v79, v7, v11
    v_add_f32_dpp v12, v8, v8 row_ror:8 row_mask:0xf bank_mask:0x3
    v_add_f32_dpp v12, v9, v9 row_ror:8 row_mask:0xf bank_mask:0xc
    v_add_f32_dpp v13, v10, v10 row_ror:8 row_mask:0xf bank_mask:0x3
    v_add_f32_dpp v13, v11, v11 row_ror:8 row_mask:0xf bank_mask:0xc
    s_nop 1
    v_add_f32_dpp v14, v12, v12 row_half_mirror row_mask:0xf bank_mask:0x5
    v_add_f32_dpp v14, v13, v13 row_half_mirror row_mask:0xf bank_mask:0xa
    s_nop 1
    v_add_f32_dpp v14, v14, v14 quad_perm:[1,0,3,2] row_mask:0xf bank_mask:0xf
    s_nop 1
    v_add_f32_dpp v16, v14, v14 quad_perm:[2,3,0,1] row_mask:0xf bank_mask:0xf
    s_waitcnt vmcnt(40)
    v_dot2_f32_bf16 v8, v80, v4, 0
    v_dot2_f32_bf16 v9, v84, v4, 0
    v_dot2_f32_bf16 v10, v88, v4, 0
    v_dot2_f32_bf16 v11, v92, v4, 0
    v_dot2_f32_bf16 v8, v81, v5, v8
    v_dot2_f32_bf16 v9, v85, v5, v9
    v_dot2_f32_bf16 v10, v89, v5, v10
    v_dot2_f32_bf16 v11, v93, v5, v11
    v_dot2_f32_bf16 v8, v82, v6, v8
    v_dot2_f32_bf16 v9, v86, v6, v9
    v_dot2_f32_bf16 v10, v90, v6, v10
    v_dot2_f32_bf16 v11, v94, v6, v11
    v_dot2_f32_bf16 v8, v83, v7, v8
    v_dot2_f32_bf16 v9, v87, v7, v9
    v_dot2_f32_bf16 v10, v91, v7, v10
    v_dot2_f32_bf16 v11, v95, v7, v11
    v_add_f32_dpp v12, v8, v8 row_ror:8 row_mask:0xf bank_mask:0x3
    v_add_f32_dpp v12, v9, v9 row_ror:8 row_mask:0xf bank_mask:0xc
    v_add_f32_dpp v13, v10, v10 row_ror:8 row_mask:0xf bank_mask:0x3
    v_add_f32_dpp v13, v11, v11 row_ror:8 row_mask:0xf bank_mask:0xc
    buffer_load_dwordx4 v[64:67], v1, s[44:47], s10 offen nt
    s_add_u32 s10, s10, 0x400
    v_add_f32_dpp v14, v12, v12 row_half_mirror row_mask:0xf bank_mask:0x5
    v_add_f32_dpp v14, v13, v13 row_half_mirror row_mask:0xf bank_mask:0xa
    s_nop 1
    v_add_f32_dpp v14, v14, v14 quad_perm:[1,0,3,2] row_mask:0xf bank_mask:0xf
    s_nop 1
    v_add_f32_dpp v15, v14, v14 quad_perm:[2,3,0,1] row_mask:0xf bank_mask:0xf
    v_cndmask_b32 v16, v16, v15, s[62:63]
    s_waitcnt vmcnt(37)
    v_dot2_f32_bf16 v8, v96, v4, 0
    v_dot2_f32_bf16 v9, v100, v4, 0
    v_dot2_f32_bf16 v10, v104, v4, 0
    v_dot2_f32_bf16 v11, v108, v4, 0
    v_dot2_f32_bf16 v8, v97, v5, v8
    v_dot2_f32_bf16 v9, v101, v5, v9
    v_dot2_f32_bf16 v10, v105, v5, v10
    v_dot2_f32_bf16 v11, v109, v5, v11
    v_dot2_f32_bf16 v8, v98, v6, v8
    v_dot2_f32_bf16 v9, v102, v6, v9
    v_dot2_f32_bf16 v10, v106, v6, v10
    v_dot2_f32_bf16 v11, v110, v6, v11
    v_dot2_f32_bf16 v8, v99, v7, v8
    v_dot2_f32_bf16 v9, v103, v7, v9
    v_dot2_f32_bf16 v10, v107, v7, v10
    v_dot2_f32_bf16 v11, v111, v7, v11
    v_add_f32_dpp v12, v8, v8 row_ror:8 row_mask:0xf bank_mask:0x3
    v_add_f32_dpp v12, v9, v9 row_ror:8 row_mask:0xf bank_mask:0xc
    v_add_f32_dpp v13, v10, v10 row_ror:8 row_mask:0xf bank_mask:0x3
    v_add_f32_dpp v13, v11, v11 row_ror:8 row_mask:0xf bank_mask:0xc
    buffer_load_dwordx4 v[68:71], v1, s[44:47], s10 offen nt
    s_add_u32 s10, s10, 0x400
    v_add_f32_dpp v14, v12, v12 row_half_mirror row_mask:0xf bank_mask:0x5
    v_add_f32_dpp v14, v13, v13 row_half_mirror row_mask:0xf bank_mask:0xa
    s_nop 1
    v_add_f32_dpp v14, v14, v14 quad_perm:[1,0,3,2] row_mask:0xf bank_mask:0xf
    s_nop 1
    v_add_f32_dpp v15, v14, v14 quad_perm:[2,3,0,1] row_mask:0xf bank_mask:0xf
    v_cndmask_b32 v16, v16, v15, s[64:65]
    s_waitcnt vmcnt(34)
    v_dot2_f32_bf16 v8, v112, v4, 0
    v_dot2_f32_bf16 v9, v116, v4, 0
    v_dot2_f32_bf16 v10, v120, v4, 0
    v_dot2_f32_bf16 v11, v124, v4, 0
    v_dot2_f32_bf16 v8, v113, v5, v8
    v_dot2_f32_bf16 v9, v117, v5, v9
    v_dot2_f32_bf16 v10, v121, v5, v10
    v_dot2_f32_bf16 v11, v125, v5, v11
    v_dot2_f32_bf16 v8, v114, v6, v8
    v_dot2_f32_bf16 v9, v118, v6, v9
    v_dot2_f32_bf16 v10, v122, v6, v10
    v_dot2_f32_bf16 v11, v126, v6, v11
    v_dot2_f32_bf16 v8, v115, v7, v8
    v_dot2_f32_bf16 v9, v119, v7, v9
    v_dot2_f32_bf16 v10, v123, v7, v10
    v_dot2_f32_bf16 v11, v127, v7, v11
    v_add_f32_dpp v12, v8, v8 row_ror:8 row_mask:0xf bank_mask:0x3
    v_add_f32_dpp v12, v9, v9 row_ror:8 row_mask:0xf bank_mask:0xc
    v_add_f32_dpp v13, v10, v10 row_ror:8 row_mask:0xf bank_mask:0x3
    v_add_f32_dpp v13, v11, v11 row_ror:8 row_mask:0xf bank_mask:0xc
    s_nop 1
    v_add_f32_dpp v14, v12, v12 row_half_mirror row_mask:0xf bank_mask:0x5
    v_add_f32_dpp v14, v13, v13 row_half_mirror row_mask:0xf bank_mask:0xa
    s_nop 1
    v_add_f32_dpp v14, v14, v14 quad_perm:[1,0,3,2] row_mask:0xf bank_mask:0xf
    s_nop 1
    v_add_f32_dpp v15, v14, v14 quad_perm:[2,3,0,1] row_mask:0xf bank_mask:0xf
    v_cndmask_b32 v16, v16, v15, s[66:67]
    v_cvt_pk_bf16_f32 v17, v16, v16
    v_lshlrev_b32 v17, 16, v17
    v_mul_f32 v17, 0x3db504f3, v17
    v_cvt_pk_bf16_f32 v17, v17, v17
    v_lshlrev_b32 v17, 16, v17
    s_add_u32 s11, s11, 1
    v_max_f32 v3, v3, v17
    ds_write_b32 v2, v17
    v_add_u32 v2, 64, v2
    s_waitcnt vmcnt(30)
    v_dot2_f32_bf16 v8, v128, v4, 0
    v_dot2_f32_bf16 v9, v132, v4, 0
    v_dot2_f32_bf16 v10, v136, v4, 0
    v_dot2_f32_bf16 v11, v140, v4, 0
    v_dot2_f32_bf16 v8, v129, v5, v8
    v_dot2_f32_bf16 v9, v133, v5, v9
    v_dot2_f32_bf16 v10, v137, v5, v10
    v_dot2_f32_bf16 v11, v141, v5, v11
    v_dot2_f32_bf16 v8, v130, v6, v8
    v_dot2_f32_bf16 v9, v134, v6, v9
    v_dot2_f32_bf16 v10, v138, v6, v10
    v_dot2_f32_bf16 v11, v142, v6, v11
    v_dot2_f32_bf16 v8, v131, v7, v8
    v_dot2_f32_bf16 v9, v135, v7, v9
    v_dot2_f32_bf16 v10, v139, v7, v10
    v_dot2_f32_bf16 v11, v143, v7, v11
    v_add_f32_dpp v12, v8, v8 row_ror:8 row_mask:0xf bank_mask:0x3
    v_add_f32_dpp v12, v9, v9 row_ror:8 row_mask:0xf bank_mask:0xc
    v_add_f32_dpp v13, v10, v10 row_ror:8 row_mask:0xf bank_mask:0x3
    v_add_f32_dpp v13, v11, v11 row_ror:8 row_mask:0xf bank_mask:0xc
    buffer_load_dwordx4 v[72:75], v1, s[44:47], s10 offen nt
    s_add_u32 s10, s10, 0x400
    v_add_f32_dpp v14, v12, v12 row_half_mirror row_mask:0xf bank_mask:0x5
    v_add_f32_dpp v14, v13, v13 row_half_mirror row_mask:0xf bank_mask:0xa
    s_nop 1
    v_add_f32_dpp v14, v14, v14 quad_perm:[1,0,3,2] row_mask:0xf bank_mask:0xf
    s_nop 1
    v_add_f32_dpp v16, v14, v14 quad_perm:[2,3,0,1] row_mask:0xf bank_mask:0xf
    s_waitcnt vmcnt(27)
    v_dot2_f32_bf16 v8, v144, v4, 0
    v_dot2_f32_bf16 v9, v148, v4, 0
    v_dot2_f32_bf16 v10, v152, v4, 0
    v_dot2_f32_bf16 v11, v156, v4, 0
    v_dot2_f32_bf16 v8, v145, v5, v8
    v_dot2_f32_bf16 v9, v149, v5, v9
    v_dot2_f32_bf16 v10, v153, v5, v10
    v_dot2_f32_bf16 v11, v157, v5, v11
    v_dot2_f32_bf16 v8, v146, v6, v8
    v_dot2_f32_bf16 v9, v150, v6, v9
    v_dot2_f32_bf16 v10, v154, v6, v10
    v_dot2_f32_bf16 v11, v158, v6, v11
    v_dot2_f32_bf16 v8, v147, v7, v8
    v_dot2_f32_bf16 v9, v151, v7, v9
    v_dot2_f32_bf16 v10, v155, v7, v10
    v_dot2_f32_bf16 v11, v159, v7, v11
    v_add_f32_dpp v12, v8, v8 row_ror:8 row_mask:0xf bank_mask:0x3
    v_add_f32_dpp v12, v9, v9 row_ror:8 row_mask:0xf bank_mask:0xc
    v_add_f32_dpp v13, v10, v10 row_ror:8 row_mask:0xf bank_mask:0x3
    v_add_f32_dpp v13, v11, v11 row_ror:8 row_mask:0xf bank_mask:0xc
    buffer_load_dwordx4 v[76:79], v1, s[44:47], s10 offen nt
    s_add_u32 s10, s10, 0x7400
    v_add_f32_dpp v14, v12, v12 row_half_mirror row_mask:0xf bank_mask:0x5
    v_add_f32_dpp v14, v13, v13 row_half_mirror row_mask:0xf bank_mask:0xa
    s_nop 1
    v_add_f32_dpp v14, v14, v14 quad_perm:[1,0,3,2] row_mask:0xf bank_mask:0xf
    s_nop 1
    v_add_f32_dpp v15, v14, v14 quad_perm:[2,3,0,1] row_mask:0xf bank_mask:0xf
    v_cndmask_b32 v16, v16, v15, s[62:63]
    s_waitcnt vmcnt(24)
    v_dot2_f32_bf16 v8, v160, v4, 0
    v_dot2_f32_bf16 v9, v164, v4, 0
    v_dot2_f32_bf16 v10, v168, v4, 0
    v_dot2_f32_bf16 v11, v172, v4, 0
    v_dot2_f32_bf16 v8, v161, v5, v8
    v_dot2_f32_bf16 v9, v165, v5, v9
    v_dot2_f32_bf16 v10, v169, v5, v10
    v_dot2_f32_bf16 v11, v173, v5, v11
    v_dot2_f32_bf16 v8, v162, v6, v8
    v_dot2_f32_bf16 v9, v166, v6, v9
    v_dot2_f32_bf16 v10, v170, v6, v10
    v_dot2_f32_bf16 v11, v174, v6, v11
    v_dot2_f32_bf16 v8, v163, v7, v8
    v_dot2_f32_bf16 v9, v167, v7, v9
    v_dot2_f32_bf16 v10, v171, v7, v10
    v_dot2_f32_bf16 v11, v175, v7, v11
    v_add_f32_dpp v12, v8, v8 row_ror:8 row_mask:0xf bank_mask:0x3
    v_add_f32_dpp v12, v9, v9 row_ror:8 row_mask:0xf bank_mask:0xc
    v_add_f32_dpp v13, v10, v10 row_ror:8 row_mask:0xf bank_mask:0x3
    v_add_f32_dpp v13, v11, v11 row_ror:8 row_mask:0xf bank_mask:0xc
    s_nop 1
    v_add_f32_dpp v14, v12, v12 row_half_mirror row_mask:0xf bank_mask:0x5
    v_add_f32_dpp v14, v13, v13 row_half_mirror row_mask:0xf bank_mask:0xa
    s_nop 1
    v_add_f32_dpp v14, v14, v14 quad_perm:[1,0,3,2] row_mask:0xf bank_mask:0xf
    s_nop 1
    v_add_f32_dpp v15, v14, v14 quad_perm:[2,3,0,1] row_mask:0xf bank_mask:0xf
    v_cndmask_b32 v16, v16, v15, s[64:65]
    s_waitcnt vmcnt(20)
    v_dot2_f32_bf16 v8, v176, v4, 0
    v_dot2_f32_bf16 v9, v180, v4, 0
    v_dot2_f32_bf16 v10, v184, v4, 0
    v_dot2_f32_bf16 v11, v188, v4, 0
    v_dot2_f32_bf16 v8, v177, v5, v8
    v_dot2_f32_bf16 v9, v181, v5, v9
    v_dot2_f32_bf16 v10, v185, v5, v10
    v_dot2_f32_bf16 v11, v189, v5, v11
    v_dot2_f32_bf16 v8, v178, v6, v8
    v_dot2_f32_bf16 v9, v182, v6, v9
    v_dot2_f32_bf16 v10, v186, v6, v10
    v_dot2_f32_bf16 v11, v190, v6, v11
    v_dot2_f32_bf16 v8, v179, v7, v8
    v_dot2_f32_bf16 v9, v183, v7, v9
    v_dot2_f32_bf16 v10, v187, v7, v10
    v_dot2_f32_bf16 v11, v191, v7, v11
    v_add_f32_dpp v12, v8, v8 row_ror:8 row_mask:0xf bank_mask:0x3
    v_add_f32_dpp v12, v9, v9 row_ror:8 row_mask:0xf bank_mask:0xc
    v_add_f32_dpp v13, v10, v10 row_ror:8 row_mask:0xf bank_mask:0x3
    v_add_f32_dpp v13, v11, v11 row_ror:8 row_mask:0xf bank_mask:0xc
    buffer_load_dwordx4 v[80:83], v1, s[44:47], s10 offen nt
    s_add_u32 s10, s10, 0x400
    v_add_f32_dpp v14, v12, v12 row_half_mirror row_mask:0xf bank_mask:0x5
    v_add_f32_dpp v14, v13, v13 row_half_mirror row_mask:0xf bank_mask:0xa
    s_nop 1
    v_add_f32_dpp v14, v14, v14 quad_perm:[1,0,3,2] row_mask:0xf bank_mask:0xf
    s_nop 1
    v_add_f32_dpp v15, v14, v14 quad_perm:[2,3,0,1] row_mask:0xf bank_mask:0xf
    v_cndmask_b32 v16, v16, v15, s[66:67]
    v_cvt_pk_bf16_f32 v17, v16, v16
    v_lshlrev_b32 v17, 16, v17
    v_mul_f32 v17, 0x3db504f3, v17
    v_cvt_pk_bf16_f32 v17, v17, v17
    v_lshlrev_b32 v17, 16, v17
    s_add_u32 s11, s11, 1
    v_max_f32 v3, v3, v17
    ds_write_b32 v2, v17
    v_add_u32 v2, 64, v2
    s_waitcnt vmcnt(17)
    v_dot2_f32_bf16 v8, v192, v4, 0
    v_dot2_f32_bf16 v9, v196, v4, 0
    v_dot2_f32_bf16 v10, v200, v4, 0
    v_dot2_f32_bf16 v11, v204, v4, 0
    v_dot2_f32_bf16 v8, v193, v5, v8
    v_dot2_f32_bf16 v9, v197, v5, v9
    v_dot2_f32_bf16 v10, v201, v5, v10
    v_dot2_f32_bf16 v11, v205, v5, v11
    v_dot2_f32_bf16 v8, v194, v6, v8
    v_dot2_f32_bf16 v9, v198, v6, v9
    v_dot2_f32_bf16 v10, v202, v6, v10
    v_dot2_f32_bf16 v11, v206, v6, v11
    v_dot2_f32_bf16 v8, v195, v7, v8
    v_dot2_f32_bf16 v9, v199, v7, v9
    v_dot2_f32_bf16 v10, v203, v7, v10
    v_dot2_f32_bf16 v11, v207, v7, v11
    v_add_f32_dpp v12, v8, v8 row_ror:8 row_mask:0xf bank_mask:0x3
    v_add_f32_dpp v12, v9, v9 row_ror:8 row_mask:0xf bank_mask:0xc
    v_add_f32_dpp v13, v10, v10 row_ror:8 row_mask:0xf bank_mask:0x3
    v_add_f32_dpp v13, v11, v11 row_ror:8 row_mask:0xf bank_mask:0xc
    buffer_load_dwordx4 v[84:87], v1, s[44:47], s10 offen nt
    s_add_u32 s10, s10, 0x400
    v_add_f32_dpp v14, v12, v12 row_half_mirror row_mask:0xf bank_mask:0x5
    v_add_f32_dpp v14, v13, v13 row_half_mirror row_mask:0xf bank_mask:0xa
    s_nop 1
    v_add_f32_dpp v14, v14, v14 quad_perm:[1,0,3,2] row_mask:0xf bank_mask:0xf
    s_nop 1
    v_add_f32_dpp v16, v14, v14 quad_perm:[2,3,0,1] row_mask:0xf bank_mask:0xf
    s_waitcnt vmcnt(14)
    v_dot2_f32_bf16 v8, v208, v4, 0
    v_dot2_f32_bf16 v9, v212, v4, 0
    v_dot2_f32_bf16 v10, v216, v4, 0
    v_dot2_f32_bf16 v11, v220, v4, 0
    v_dot2_f32_bf16 v8, v209, v5, v8
    v_dot2_f32_bf16 v9, v213, v5, v9
    v_dot2_f32_bf16 v10, v217, v5, v10
    v_dot2_f32_bf16 v11, v221, v5, v11
    v_dot2_f32_bf16 v8, v210, v6, v8
    v_dot2_f32_bf16 v9, v214, v6, v9
    v_dot2_f32_bf16 v10, v218, v6, v10
    v_dot2_f32_bf16 v11, v222, v6, v11
    v_dot2_f32_bf16 v8, v211, v7, v8
    v_dot2_f32_bf16 v9, v215, v7, v9
    v_dot2_f32_bf16 v10, v219, v7, v10
    v_dot2_f32_bf16 v11, v223, v7, v11
    v_add_f32_dpp v12, v8, v8 row_ror:8 row_mask:0xf bank_mask:0x3
    v_add_f32_dpp v12, v9, v9 row_ror:8 row_mask:0xf bank_mask:0xc
    v_add_f32_dpp v13, v10, v10 row_ror:8 row_mask:0xf bank_mask:0x3
    v_add_f32_dpp v13, v11, v11 row_ror:8 row_mask:0xf bank_mask:0xc
    s_nop 1
    v_add_f32_dpp v14, v12, v12 row_half_mirror row_mask:0xf bank_mask:0x5
    v_add_f32_dpp v14, v13, v13 row_half_mirror row_mask:0xf bank_mask:0xa
    s_nop 1
    v_add_f32_dpp v14, v14, v14 quad_perm:[1,0,3,2] row_mask:0xf bank_mask:0xf
    s_nop 1
    v_add_f32_dpp v15, v14, v14 quad_perm:[2,3,0,1] row_mask:0xf bank_mask:0xf
    v_cndmask_b32 v16, v16, v15, s[62:63]
    s_waitcnt vmcnt(10)
    v_dot2_f32_bf16 v8, v224, v4, 0
    v_dot2_f32_bf16 v9, v228, v4, 0
    v_dot2_f32_bf16 v10, v232, v4, 0
    v_dot2_f32_bf16 v11, v236, v4, 0
    v_dot2_f32_bf16 v8, v225, v5, v8
    v_dot2_f32_bf16 v9, v229, v5, v9
    v_dot2_f32_bf16 v10, v233, v5, v10
    v_dot2_f32_bf16 v11, v237, v5, v11
    v_dot2_f32_bf16 v8, v226, v6, v8
    v_dot2_f32_bf16 v9, v230, v6, v9
    v_dot2_f32_bf16 v10, v234, v6, v10
    v_dot2_f32_bf16 v11, v238, v6, v11
    v_dot2_f32_bf16 v8, v227, v7, v8
    v_dot2_f32_bf16 v9, v231, v7, v9
    v_dot2_f32_bf16 v10, v235, v7, v10
    v_dot2_f32_bf16 v11, v239, v7, v11
    v_add_f32_dpp v12, v8, v8 row_ror:8 row_mask:0xf bank_mask:0x3
    v_add_f32_dpp v12, v9, v9 row_ror:8 row_mask:0xf bank_mask:0xc
    v_add_f32_dpp v13, v10, v10 row_ror:8 row_mask:0xf bank_mask:0x3
    v_add_f32_dpp v13, v11, v11 row_ror:8 row_mask:0xf bank_mask:0xc
    buffer_load_dwordx4 v[88:91], v1, s[44:47], s10 offen nt
    s_add_u32 s10, s10, 0x400
    v_add_f32_dpp v14, v12, v12 row_half_mirror row_mask:0xf bank_mask:0x5
    v_add_f32_dpp v14, v13, v13 row_half_mirror row_mask:0xf bank_mask:0xa
    s_nop 1
    v_add_f32_dpp v14, v14, v14 quad_perm:[1,0,3,2] row_mask:0xf bank_mask:0xf
    s_nop 1
    v_add_f32_dpp v15, v14, v14 quad_perm:[2,3,0,1] row_mask:0xf bank_mask:0xf
    v_cndmask_b32 v16, v16, v15, s[64:65]
    s_waitcnt vmcnt(7)
    v_dot2_f32_bf16 v8, v240, v4, 0
    v_dot2_f32_bf16 v9, v244, v4, 0
    v_dot2_f32_bf16 v10, v248, v4, 0
    v_dot2_f32_bf16 v11, v252, v4, 0
    v_dot2_f32_bf16 v8, v241, v5, v8
    v_dot2_f32_bf16 v9, v245, v5, v9
    v_dot2_f32_bf16 v10, v249, v5, v10
    v_dot2_f32_bf16 v11, v253, v5, v11
    v_dot2_f32_bf16 v8, v242, v6, v8
    v_dot2_f32_bf16 v9, v246, v6, v9
    v_dot2_f32_bf16 v10, v250, v6, v10
    v_dot2_f32_bf16 v11, v254, v6, v11
    v_dot2_f32_bf16 v8, v243, v7, v8
    v_dot2_f32_bf16 v9, v247, v7, v9
    v_dot2_f32_bf16 v10, v251, v7, v10
    v_dot2_f32_bf16 v11, v255, v7, v11
    v_add_f32_dpp v12, v8, v8 row_ror:8 row_mask:0xf bank_mask:0x3
    v_add_f32_dpp v12, v9, v9 row_ror:8 row_mask:0xf bank_mask:0xc
    v_add_f32_dpp v13, v10, v10 row_ror:8 row_mask:0xf bank_mask:0x3
    v_add_f32_dpp v13, v11, v11 row_ror:8 row_mask:0xf bank_mask:0xc
    buffer_load_dwordx4 v[92:95], v1, s[44:47], s10 offen nt
    s_add_u32 s10, s10, s76
    v_add_f32_dpp v14, v12, v12 row_half_mirror row_mask:0xf bank_mask:0x5
    v_add_f32_dpp v14, v13, v13 row_half_mirror row_mask:0xf bank_mask:0xa
    s_nop 1
    v_add_f32_dpp v14, v14, v14 quad_perm:[1,0,3,2] row_mask:0xf bank_mask:0xf
    s_nop 1
    v_add_f32_dpp v15, v14, v14 quad_perm:[2,3,0,1] row_mask:0xf bank_mask:0xf
    v_cndmask_b32 v16, v16, v15, s[66:67]
    v_cvt_pk_bf16_f32 v17, v16, v16
    v_lshlrev_b32 v17, 16, v17
    v_mul_f32 v17, 0x3db504f3, v17
    v_cvt_pk_bf16_f32 v17, v17, v17
    v_lshlrev_b32 v17, 16, v17
    s_add_u32 s11, s11, 1
    v_max_f32 v3, v3, v17
    ds_write_b32 v2, v17
    v_add_u32 v2, 64, v2
    s_branch L_kn
L_k2:
    s_waitcnt vmcnt(2)
    v_dot2_f32_bf16 v8, v64, v4, 0
    v_dot2_f32_bf16 v9, v68, v4, 0
    v_dot2_f32_bf16 v10, v72, v4, 0
    v_dot2_f32_bf16 v11, v76, v4, 0
    v_dot2_f32_bf16 v8, v65, v5, v8
    v_dot2_f32_bf16 v9, v69, v5, v9
    v_dot2_f32_bf16 v10, v73, v5, v10
    v_dot2_f32_bf16 v11, v77, v5, v11
    v_dot2_f32_bf16 v8, v66, v6, v8
    v_dot2_f32_bf16 v9, v70, v6, v9
    v_dot2_f32_bf16 v10, v74, v6, v10
    v_dot2_f32_bf16 v11, v78, v6, v11
    v_dot2_f32_bf16 v8, v67, v7, v8
    v_dot2_f32_bf16 v9, v71, v7, v9
    v_dot2_f32_bf16 v10, v75, v7, v10
    v_dot2_f32_bf16 v11, v79, v7, v11
    v_add_f32_dpp v12, v8, v8 row_ror:8 row_mask:0xf bank_mask:0x3
    v_add_f32_dpp v12, v9, v9 row_ror:8 row_mask:0xf bank_mask:0xc
    v_add_f32_dpp v13, v10, v10 row_ror:8 row_mask:0xf bank_mask:0x3
    v_add_f32_dpp v13, v11, v11 row_ror:8 row_mask:0xf bank_mask:0xc
    buffer_load_dwordx4 v[96:99], v1, s[44:47], s10 offen nt
    s_add_u32 s10, s10, 0x400
    v_add_f32_dpp v14, v12, v12 row_half_mirror row_mask:0xf bank_mask:0x5
    v_add_f32_dpp v14, v13, v13 row_half_mirror row_mask:0xf bank_mask:0xa
    buffer_load_dwordx4 v[100:103], v1, s[44:47], s10 offen nt
    s_add_u32 s10, s10, 0x400
    v_add_f32_dpp v14, v14, v14 quad_perm:[1,0,3,2] row_mask:0xf bank_mask:0xf
    buffer_load_dwordx4 v[104:107], v1, s[44:47], s10 offen nt
    s_add_u32 s10, s10, 0x400
    v_add_f32_dpp v16, v14, v14 quad_perm:[2,3,0,1] row_mask:0xf bank_mask:0xf
    buffer_load_dwordx4 v[108:111], v1, s[44:47], s10 offen nt
    s_add_u32 s10, s10, 0x7400
    s_waitcnt vmcnt(2)
    v_dot2_f32_bf16 v8, v80, v4, 0
    v_dot2_f32_bf16 v9, v84, v4, 0
    v_dot2_f32_bf16 v10, v88, v4, 0
    v_dot2_f32_bf16 v11, v92, v4, 0
    v_dot2_f32_bf16 v8, v81, v5, v8
    v_dot2_f32_bf16 v9, v85, v5, v9
    v_dot2_f32_bf16 v10, v89, v5, v10
    v_dot2_f32_bf16 v11, v93, v5, v11
    v_dot2_f32_bf16 v8, v82, v6, v8
    v_dot2_f32_bf16 v9, v86, v6, v9
    v_dot2_f32_bf16 v10, v90, v6, v10
    v_dot2_f32_bf16 v11, v94, v6, v11
    v_dot2_f32_bf16 v8, v83, v7, v8
    v_dot2_f32_bf16 v9, v87, v7, v9
    v_dot2_f32_bf16 v10, v91, v7, v10
    v_dot2_f32_bf16 v11, v95, v7, v11
    v_add_f32_dpp v12, v8, v8 row_ror:8 row_mask:0xf bank_mask:0x3
    v_add_f32_dpp v12, v9, v9 row_ror:8 row_mask:0xf bank_mask:0xc
    v_add_f32_dpp v13, v10, v10 row_ror:8 row_mask:0xf bank_mask:0x3
    v_add_f32_dpp v13, v11, v11 row_ror:8 row_mask:0xf bank_mask:0xc
    buffer_load_dwordx4 v[112:115], v1, s[44:47], s10 offen nt
    s_add_u32 s10, s10, 0x400
    v_add_f32_dpp v14, v12, v12 row_half_mirror row_mask:0xf bank_mask:0x5
    v_add_f32_dpp v14, v13, v13 row_half_mirror row_mask:0xf bank_mask:0xa
    buffer_load_dwordx4 v[116:119], v1, s[44:47], s10 offen nt
    s_add_u32 s10, s10, 0x400
    v_add_f32_dpp v14, v14, v14 quad_perm:[1,0,3,2] row_mask:0xf bank_mask:0xf
    buffer_load_dwordx4 v[120:123], v1, s[44:47], s10 offen nt
    s_add_u32 s10, s10, 0x400
    v_add_f32_dpp v15, v14, v14 quad_perm:[2,3,0,1] row_mask:0xf bank_mask:0xf
    buffer_load_dwordx4 v[124:127], v1, s[44:47], s10 offen nt
    s_add_u32 s10, s10, s77
    v_cndmask_b32 v16, v16, v15, s[62:63]
    s_waitcnt vmcnt(2)
    v_dot2_f32_bf16 v8, v96, v4, 0
    v_dot2_f32_bf16 v9, v100, v4, 0
    v_dot2_f32_bf16 v10, v104, v4, 0
    v_dot2_f32_bf16 v11, v108, v4, 0
    v_dot2_f32_bf16 v8, v97, v5, v8
    v_dot2_f32_bf16 v9, v101, v5, v9
    v_dot2_f32_bf16 v10, v105, v5, v10
    v_dot2_f32_bf16 v11, v109, v5, v11
    v_dot2_f32_bf16 v8, v98, v6, v8
    v_dot2_f32_bf16 v9, v102, v6, v9
    v_dot2_f32_bf16 v10, v106, v6, v10
    v_dot2_f32_bf16 v11, v110, v6, v11
    v_dot2_f32_bf16 v8, v99, v7, v8
    v_dot2_f32_bf16 v9, v103, v7, v9
    v_dot2_f32_bf16 v10, v107, v7, v10
    v_dot2_f32_bf16 v11, v111, v7, v11
    s_cmp_eq_u32 s11, 7
    s_cselect_b32 s44, s42, s44
    s_cselect_b32 s45, s43, s45
    s_cselect_b32 s10, s78, s10
    v_add_f32_dpp v12, v8, v8 row_ror:8 row_mask:0xf bank_mask:0x3
    v_add_f32_dpp v12, v9, v9 row_ror:8 row_mask:0xf bank_mask:0xc
    v_add_f32_dpp v13, v10, v10 row_ror:8 row_mask:0xf bank_mask:0x3
    v_add_f32_dpp v13, v11, v11 row_ror:8 row_mask:0xf bank_mask:0xc
    buffer_load_dwordx4 v[64:67], v1, s[44:47], s10 offen nt
    s_add_u32 s10, s10, 0x400
    v_add_f32_dpp v14, v12, v12 row_half_mirror row_mask:0xf bank_mask:0x5
    v_add_f32_dpp v14, v13, v13 row_half_mirror row_mask:0xf bank_mask:0xa
    buffer_load_dwordx4 v[68:71], v1, s[44:47], s10 offen nt
    s_add_u32 s10, s10, 0x400
    v_add_f32_dpp v14, v14, v14 quad_perm:[1,0,3,2] row_mask:0xf bank_mask:0xf
    buffer_load_dwordx4 v[72:75], v1, s[44:47], s10 offen nt
    s_add_u32 s10, s10, 0x400
    v_add_f32_dpp v15, v14, v14 quad_perm:[2,3,0,1] row_mask:0xf bank_mask:0xf
    buffer_load_dwordx4 v[76:79], v1, s[44:47], s10 offen nt
    s_add_u32 s10, s10, 0x7400
    v_cndmask_b32 v16, v16, v15, s[64:65]
    s_waitcnt vmcnt(2)
    v_dot2_f32_bf16 v8, v112, v4, 0
    v_dot2_f32_bf16 v9, v116, v4, 0
    v_dot2_f32_bf16 v10, v120, v4, 0
    v_dot2_f32_bf16 v11, v124, v4, 0
    v_dot2_f32_bf16 v8, v113, v5, v8
    v_dot2_f32_bf16 v9, v117, v5, v9
    v_dot2_f32_bf16 v10, v121, v5, v10
    v_dot2_f32_bf16 v11, v125, v5, v11
    v_dot2_f32_bf16 v8, v114, v6, v8
    v_dot2_f32_bf16 v9, v118, v6, v9
    v_dot2_f32_bf16 v10, v122, v6, v10
    v_dot2_f32_bf16 v11, v126, v6, v11
    v_dot2_f32_bf16 v8, v115, v7, v8
    v_dot2_f32_bf16 v9, v119, v7, v9
    v_dot2_f32_bf16 v10, v123, v7, v10
    v_dot2_f32_bf16 v11, v127, v7, v11
    v_add_f32_dpp v12, v8, v8 row_ror:8 row_mask:0xf bank_mask:0x3
    v_add_f32_dpp v12, v9, v9 row_ror:8 row_mask:0xf bank_mask:0xc
    v_add_f32_dpp v13, v10, v10 row_ror:8 row_mask:0xf bank_mask:0x3
    v_add_f32_dpp v13, v11, v11 row_ror:8 row_mask:0xf bank_mask:0xc
    buffer_load_dwordx4 v[80:83], v1, s[44:47], s10 offen nt
    s_add_u32 s10, s10, 0x400
    v_add_f32_dpp v14, v12, v12 row_half_mirror row_mask:0xf bank_mask:0x5
    v_add_f32_dpp v14, v13, v13 row_half_mirror row_mask:0xf bank_mask:0xa
    buffer_load_dwordx4 v[84:87], v1, s[44:47], s10 offen nt
    s_add_u32 s10, s10, 0x400
    v_add_f32_dpp v14, v14, v14 quad_perm:[1,0,3,2] row_mask:0xf bank_mask:0xf
    buffer_load_dwordx4 v[88:91], v1, s[44:47], s10 offen nt
    s_add_u32 s10, s10, 0x400
    v_add_f32_dpp v15, v14, v14 quad_perm:[2,3,0,1] row_mask:0xf bank_mask:0xf
    buffer_load_dwordx4 v[92:95], v1, s[44:47], s10 offen nt
    s_add_u32 s10, s10, s76
    v_cndmask_b32 v16, v16, v15, s[66:67]
    v_cvt_pk_bf16_f32 v17, v16, v16
    v_lshlrev_b32 v17, 16, v17
    v_mul_f32 v17, 0x3db504f3, v17
    v_cvt_pk_bf16_f32 v17, v17, v17
    v_lshlrev_b32 v17, 16, v17
    s_add_u32 s11, s11, 1
    v_max_f32 v3, v3, v17
    ds_read_b32 v41, v30 offset:10932
    ds_write_b32 v2, v17
    v_add_u32 v2, 64, v2
    s_memrealtime s[70:71]
    s_mov_b64 exec, 1
    ds_add_u32 v30, v40 offset:10924
    s_mov_b64 exec, -1
    s_waitcnt lgkmcnt(0)
    v_readfirstlane_b32 s71, v41
    s_sub_u32 s70, s68, s70
    s_add_u32 s70, s70, s71
    s_add_u32 s68, s68, 235
    s_cmp_gt_i32 s70, -10
    s_cselect_b32 s69, 1, 0
    s_cmp_gt_i32 s70, 60
    s_cselect_b32 s69, 2, s69
    s_cmp_eq_u32 s71, 0
    s_cselect_b32 s69, 0, s69
    s_branch L_kc
L_k1:
    s_waitcnt vmcnt(3)
    v_dot2_f32_bf16 v8, v64, v4, 0
    v_dot2_f32_bf16 v9, v68, v4, 0
    v_dot2_f32_bf16 v10, v72, v4, 0
    v_dot2_f32_bf16 v11, v76, v4, 0
    v_dot2_f32_bf16 v8, v65, v5, v8
    v_dot2_f32_bf16 v9, v69, v5, v9
    v_dot2_f32_bf16 v10, v73, v5, v10
    v_dot2_f32_bf16 v11, v77, v5, v11
    v_dot2_f32_bf16 v8, v66, v6, v8
    v_dot2_f32_bf16 v9, v70, v6, v9
    v_dot2_f32_bf16 v10, v74, v6, v10
    v_dot2_f32_bf16 v11, v78, v6, v11
    v_dot2_f32_bf16 v8, v67, v7, v8
    v_dot2_f32_bf16 v9, v71, v7, v9
    v_dot2_f32_bf16 v10, v75, v7, v10
    v_dot2_f32_bf16 v11, v79, v7, v11
    v_add_f32_dpp v12, v8, v8 row_ror:8 row_mask:0xf bank_mask:0x3
    v_add_f32_dpp v12, v9, v9 row_ror:8 row_mask:0xf bank_mask:0xc
    v_add_f32_dpp v13, v10, v10 row_ror:8 row_mask:0xf bank_mask:0x3
    v_add_f32_dpp v13, v11, v11 row_ror:8 row_mask:0xf bank_mask:0xc
    buffer_load_dwordx4 v[96:99], v1, s[44:47], s10 offen nt
    s_add_u32 s10, s10, 0x400
    v_add_f32_dpp v14, v12, v12 row_half_mirror row_mask:0xf bank_mask:0x5
    v_add_f32_dpp v14, v13, v13 row_half_mirror row_mask:0xf bank_mask:0xa
    buffer_load_dwordx4 v[100:103], v1, s[44:47], s10 offen nt
    s_add_u32 s10, s10, 0x400
    v_add_f32_dpp v14, v14, v14 quad_perm:[1,0,3,2] row_mask:0xf bank_mask:0xf
    buffer_load_dwordx4 v[104:107], v1, s[44:47], s10 offen nt
    s_add_u32 s10, s10, 0x400
    v_add_f32_dpp v16, v14, v14 quad_perm:[2,3,0,1] row_mask:0xf bank_mask:0xf
    buffer_load_dwordx4 v[108:111], v1, s[44:47], s10 offen nt
    s_add_u32 s10, s10, 0x7400
    s_waitcnt vmcnt(3)
    v_dot2_f32_bf16 v8, v80, v4, 0
    v_dot2_f32_bf16 v9, v84, v4, 0
    v_dot2_f32_bf16 v10, v88, v4, 0
    v_dot2_f32_bf16 v11, v92, v4, 0
    v_dot2_f32_bf16 v8, v81, v5, v8
    v_dot2_f32_bf16 v9, v85, v5, v9
    v_dot2_f32_bf16 v10, v89, v5, v10
    v_dot2_f32_bf16 v11, v93, v5, v11
    v_dot2_f32_bf16 v8, v82, v6, v8
    v_dot2_f32_bf16 v9, v86, v6, v9
    v_dot2_f32_bf16 v10, v90, v6, v10
    v_dot2_f32_bf16 v11, v94, v6, v11
    v_dot2_f32_bf16 v8, v83, v7, v8
    v_dot2_f32_bf16 v9, v87, v7, v9
    v_dot2_f32_bf16 v10, v91, v7, v10
    v_dot2_f32_bf16 v11, v95, v7, v11
    v_add_f32_dpp v12, v8, v8 row_ror:8 row_mask:0xf bank_mask:0x3
    v_add_f32_dpp v12, v9, v9 row_ror:8 row_mask:0xf bank_mask:0xc
    v_add_f32_dpp v13, v10, v10 row_ror:8 row_mask:0xf bank_mask:0x3
    v_add_f32_dpp v13, v11, v11 row_ror:8 row_mask:0xf bank_mask:0xc
    buffer_load_dwordx4 v[112:115], v1, s[44:47], s10 offen nt
    s_add_u32 s10, s10, 0x400
    v_add_f32_dpp v14, v12, v12 row_half_mirror row_mask:0xf bank_mask:0x5
    v_add_f32_dpp v14, v13, v13 row_half_mirror row_mask:0xf bank_mask:0xa
    buffer_load_dwordx4 v[116:119], v1, s[44:47], s10 offen nt
    s_add_u32 s10, s10, 0x400
    v_add_f32_dpp v14, v14, v14 quad_perm:[1,0,3,2] row_mask:0xf bank_mask:0xf
    buffer_load_dwordx4 v[120:123], v1, s[44:47], s10 offen nt
    s_add_u32 s10, s10, 0x400
    v_add_f32_dpp v15, v14, v14 quad_perm:[2,3,0,1] row_mask:0xf bank_mask:0xf
    buffer_load_dwordx4 v[124:127], v1, s[44:47], s10 offen nt
    s_add_u32 s10, s10, s77
    v_cndmask_b32 v16, v16, v15, s[62:63]
    s_waitcnt vmcnt(3)
    v_dot2_f32_bf16 v8, v96, v4, 0
    v_dot2_f32_bf16 v9, v100, v4, 0
    v_dot2_f32_bf16 v10, v104, v4, 0
    v_dot2_f32_bf16 v11, v108, v4, 0
    v_dot2_f32_bf16 v8, v97, v5, v8
    v_dot2_f32_bf16 v9, v101, v5, v9
    v_dot2_f32_bf16 v10, v105, v5, v10
    v_dot2_f32_bf16 v11, v109, v5, v11
    v_dot2_f32_bf16 v8, v98, v6, v8
    v_dot2_f32_bf16 v9, v102, v6, v9
    v_dot2_f32_bf16 v10, v106, v6, v10
    v_dot2_f32_bf16 v11, v110, v6, v11
    v_dot2_f32_bf16 v8, v99, v7, v8
    v_dot2_f32_bf16 v9, v103, v7, v9
    v_dot2_f32_bf16 v10, v107, v7, v10
    v_dot2_f32_bf16 v11, v111, v7, v11
    s_cmp_eq_u32 s11, 7
    s_cselect_b32 s44, s42, s44
    s_cselect_b32 s45, s43, s45
    s_cselect_b32 s10, s78, s10
    v_add_f32_dpp v12, v8, v8 row_ror:8 row_mask:0xf bank_mask:0x3
    v_add_f32_dpp v12, v9, v9 row_ror:8 row_mask:0xf bank_mask:0xc
    v_add_f32_dpp v13, v10, v10 row_ror:8 row_mask:0xf bank_mask:0x3
    v_add_f32_dpp v13, v11, v11 row_ror:8 row_mask:0xf bank_mask:0xc
    buffer_load_dwordx4 v[64:67], v1, s[44:47], s10 offen nt
    s_add_u32 s10, s10, 0x400
    v_add_f32_dpp v14, v12, v12 row_half_mirror row_mask:0xf bank_mask:0x5
    v_add_f32_dpp v14, v13, v13 row_half_mirror row_mask:0xf bank_mask:0xa
    buffer_load_dwordx4 v[68:71], v1, s[44:47], s10 offen nt
    s_add_u32 s10, s10, 0x400
    v_add_f32_dpp v14, v14, v14 quad_perm:[1,0,3,2] row_mask:0xf bank_mask:0xf
    buffer_load_dwordx4 v[72:75], v1, s[44:47], s10 offen nt
    s_add_u32 s10, s10, 0x400
    v_add_f32_dpp v15, v14, v14 quad_perm:[2,3,0,1] row_mask:0xf bank_mask:0xf
    buffer_load_dwordx4 v[76:79], v1, s[44:47], s10 offen nt
    s_add_u32 s10, s10, 0x7400
    v_cndmask_b32 v16, v16, v15, s[64:65]
    s_waitcnt vmcnt(3)
    v_dot2_f32_bf16 v8, v112, v4, 0
    v_dot2_f32_bf16 v9, v116, v4, 0
    v_dot2_f32_bf16 v10, v120, v4, 0
    v_dot2_f32_bf16 v11, v124, v4, 0
    v_dot2_f32_bf16 v8, v113, v5, v8
    v_dot2_f32_bf16 v9, v117, v5, v9
    v_dot2_f32_bf16 v10, v121, v5, v10
    v_dot2_f32_bf16 v11, v125, v5, v11
    v_dot2_f32_bf16 v8, v114, v6, v8
    v_dot2_f32_bf16 v9, v118, v6, v9
    v_dot2_f32_bf16 v10, v122, v6, v10
    v_dot2_f32_bf16 v11, v126, v6, v11
    v_dot2_f32_bf16 v8, v115, v7, v8
    v_dot2_f32_bf16 v9, v119, v7, v9
    v_dot2_f32_bf16 v10, v123, v7, v10
    v_dot2_f32_bf16 v11, v127, v7, v11
    v_add_f32_dpp v12, v8, v8 row_ror:8 row_mask:0xf bank_mask:0x3
    v_add_f32_dpp v12, v9, v9 row_ror:8 row_mask:0xf bank_mask:0xc
    v_add_f32_dpp v13, v10, v10 row_ror:8 row_mask:0xf bank_mask:0x3
    v_add_f32_dpp v13, v11, v11 row_ror:8 row_mask:0xf bank_mask:0xc
    buffer_load_dwordx4 v[80:83], v1, s[44:47], s10 offen nt
    s_add_u32 s10, s10, 0x400
    v_add_f32_dpp v14, v12, v12 row_half_mirror row_mask:0xf bank_mask:0x5
    v_add_f32_dpp v14, v13, v13 row_half_mirror row_mask:0xf bank_mask:0xa
    buffer_load_dwordx4 v[84:87], v1, s[44:47], s10 offen nt
    s_add_u32 s10, s10, 0x400
    v_add_f32_dpp v14, v14, v14 quad_perm:[1,0,3,2] row_mask:0xf bank_mask:0xf
    buffer_load_dwordx4 v[88:91], v1, s[44:47], s10 offen nt
    s_add_u32 s10, s10, 0x400
    v_add_f32_dpp v15, v14, v14 quad_perm:[2,3,0,1] row_mask:0xf bank_mask:0xf
    buffer_load_dwordx4 v[92:95], v1, s[44:47], s10 offen nt
    s_add_u32 s10, s10, s76
    v_cndmask_b32 v16, v16, v15, s[66:67]
    v_cvt_pk_bf16_f32 v17, v16, v16
    v_lshlrev_b32 v17, 16, v17
    v_mul_f32 v17, 0x3db504f3, v17
    v_cvt_pk_bf16_f32 v17, v17, v17
    v_lshlrev_b32 v17, 16, v17
    s_add_u32 s11, s11, 1
    v_max_f32 v3, v3, v17
    ds_read_b32 v41, v30 offset:10932
    ds_write_b32 v2, v17
    v_add_u32 v2, 64, v2
    s_memrealtime s[70:71]
    s_mov_b64 exec, 1
    ds_add_u32 v30, v40 offset:10924
    s_mov_b64 exec, -1
    s_waitcnt lgkmcnt(0)
    v_readfirstlane_b32 s71, v41
    s_sub_u32 s70, s68, s70
    s_add_u32 s70, s70, s71
    s_add_u32 s68, s68, 235
    s_cmp_gt_i32 s70, -10
    s_cselect_b32 s69, 1, 0
    s_cmp_gt_i32 s70, 60
    s_cselect_b32 s69, 2, s69
    s_cmp_eq_u32 s71, 0
    s_cselect_b32 s69, 0, s69
    s_branch L_kc
L_k0:
    s_waitcnt vmcnt(4)
    v_dot2_f32_bf16 v8, v64, v4, 0
    v_dot2_f32_bf16 v9, v68, v4, 0
    v_dot2_f32_bf16 v10, v72, v4, 0
    v_dot2_f32_bf16 v11, v76, v4, 0
    v_dot2_f32_bf16 v8, v65, v5, v8
    v_dot2_f32_bf16 v9, v69, v5, v9
    v_dot2_f32_bf16 v10, v73, v5, v10
    v_dot2_f32_bf16 v11, v77, v5, v11
    v_dot2_f32_bf16 v8, v66, v6, v8
    v_dot2_f32_bf16 v9, v70, v6, v9
    v_dot2_f32_bf16 v10, v74, v6, v10
    v_dot2_f32_bf16 v11, v78, v6, v11
    v_dot2_f32_bf16 v8, v67, v7, v8
    v_dot2_f32_bf16 v9, v71, v7, v9
    v_dot2_f32_bf16 v10, v75, v7, v10
    v_dot2_f32_bf16 v11, v79, v7, v11
    v_add_f32_dpp v12, v8, v8 row_ror:8 row_mask:0xf bank_mask:0x3
    v_add_f32_dpp v12, v9, v9 row_ror:8 row_mask:0xf bank_mask:0xc
    v_add_f32_dpp v13, v10, v10 row_ror:8 row_mask:0xf bank_mask:0x3
    v_add_f32_dpp v13, v11, v11 row_ror:8 row_mask:0xf bank_mask:0xc
    buffer_load_dwordx4 v[96:99], v1, s[44:47], s10 offen nt
    s_add_u32 s10, s10, 0x400
    v_add_f32_dpp v14, v12, v12 row_half_mirror row_mask:0xf bank_mask:0x5
    v_add_f32_dpp v14, v13, v13 row_half_mirror row_mask:0xf bank_mask:0xa
    buffer_load_dwordx4 v[100:103], v1, s[44:47], s10 offen nt
    s_add_u32 s10, s10, 0x400
    v_add_f32_dpp v14, v14, v14 quad_perm:[1,0,3,2] row_mask:0xf bank_mask:0xf
    buffer_load_dwordx4 v[104:107], v1, s[44:47], s10 offen nt
    s_add_u32 s10, s10, 0x400
    v_add_f32_dpp v16, v14, v14 quad_perm:[2,3,0,1] row_mask:0xf bank_mask:0xf
    buffer_load_dwordx4 v[108:111], v1, s[44:47], s10 offen nt
    s_add_u32 s10, s10, 0x7400
    s_waitcnt vmcnt(4)
    v_dot2_f32_bf16 v8, v80, v4, 0
    v_dot2_f32_bf16 v9, v84, v4, 0
    v_dot2_f32_bf16 v10, v88, v4, 0
    v_dot2_f32_bf16 v11, v92, v4, 0
    v_dot2_f32_bf16 v8, v81, v5, v8
    v_dot2_f32_bf16 v9, v85, v5, v9
    v_dot2_f32_bf16 v10, v89, v5, v10
    v_dot2_f32_bf16 v11, v93, v5, v11
    v_dot2_f32_bf16 v8, v82, v6, v8
    v_dot2_f32_bf16 v9, v86, v6, v9
    v_dot2_f32_bf16 v10, v90, v6, v10
    v_dot2_f32_bf16 v11, v94, v6, v11
    v_dot2_f32_bf16 v8, v83, v7, v8
    v_dot2_f32_bf16 v9, v87, v7, v9
    v_dot2_f32_bf16 v10, v91, v7, v10
    v_dot2_f32_bf16 v11, v95, v7, v11
    v_add_f32_dpp v12, v8, v8 row_ror:8 row_mask:0xf bank_mask:0x3
    v_add_f32_dpp v12, v9, v9 row_ror:8 row_mask:0xf bank_mask:0xc
    v_add_f32_dpp v13, v10, v10 row_ror:8 row_mask:0xf bank_mask:0x3
    v_add_f32_dpp v13, v11, v11 row_ror:8 row_mask:0xf bank_mask:0xc
    buffer_load_dwordx4 v[112:115], v1, s[44:47], s10 offen nt
    s_add_u32 s10, s10, 0x400
    v_add_f32_dpp v14, v12, v12 row_half_mirror row_mask:0xf bank_mask:0x5
    v_add_f32_dpp v14, v13, v13 row_half_mirror row_mask:0xf bank_mask:0xa
    buffer_load_dwordx4 v[116:119], v1, s[44:47], s10 offen nt
    s_add_u32 s10, s10, 0x400
    v_add_f32_dpp v14, v14, v14 quad_perm:[1,0,3,2] row_mask:0xf bank_mask:0xf
    buffer_load_dwordx4 v[120:123], v1, s[44:47], s10 offen nt
    s_add_u32 s10, s10, 0x400
    v_add_f32_dpp v15, v14, v14 quad_perm:[2,3,0,1] row_mask:0xf bank_mask:0xf
    buffer_load_dwordx4 v[124:127], v1, s[44:47], s10 offen nt
    s_add_u32 s10, s10, s77
    v_cndmask_b32 v16, v16, v15, s[62:63]
    s_waitcnt vmcnt(4)
    v_dot2_f32_bf16 v8, v96, v4, 0
    v_dot2_f32_bf16 v9, v100, v4, 0
    v_dot2_f32_bf16 v10, v104, v4, 0
    v_dot2_f32_bf16 v11, v108, v4, 0
    v_dot2_f32_bf16 v8, v97, v5, v8
    v_dot2_f32_bf16 v9, v101, v5, v9
    v_dot2_f32_bf16 v10, v105, v5, v10
    v_dot2_f32_bf16 v11, v109, v5, v11
    v_dot2_f32_bf16 v8, v98, v6, v8
    v_dot2_f32_bf16 v9, v102, v6, v9
    v_dot2_f32_bf16 v10, v106, v6, v10
    v_dot2_f32_bf16 v11, v110, v6, v11
    v_dot2_f32_bf16 v8, v99, v7, v8
    v_dot2_f32_bf16 v9, v103, v7, v9
    v_dot2_f32_bf16 v10, v107, v7, v10
    v_dot2_f32_bf16 v11, v111, v7, v11
    s_cmp_eq_u32 s11, 7
    s_cselect_b32 s44, s42, s44
    s_cselect_b32 s45, s43, s45
    s_cselect_b32 s10, s78, s10
    v_add_f32_dpp v12, v8, v8 row_ror:8 row_mask:0xf bank_mask:0x3
    v_add_f32_dpp v12, v9, v9 row_ror:8 row_mask:0xf bank_mask:0xc
    v_add_f32_dpp v13, v10, v10 row_ror:8 row_mask:0xf bank_mask:0x3
    v_add_f32_dpp v13, v11, v11 row_ror:8 row_mask:0xf bank_mask:0xc
    buffer_load_dwordx4 v[64:67], v1, s[44:47], s10 offen nt
    s_add_u32 s10, s10, 0x400
    v_add_f32_dpp v14, v12, v12 row_half_mirror row_mask:0xf bank_mask:0x5
    v_add_f32_dpp v14, v13, v13 row_half_mirror row_mask:0xf bank_mask:0xa
    buffer_load_dwordx4 v[68:71], v1, s[44:47], s10 offen nt
    s_add_u32 s10, s10, 0x400
    v_add_f32_dpp v14, v14, v14 quad_perm:[1,0,3,2] row_mask:0xf bank_mask:0xf
    buffer_load_dwordx4 v[72:75], v1, s[44:47], s10 offen nt
    s_add_u32 s10, s10, 0x400
    v_add_f32_dpp v15, v14, v14 quad_perm:[2,3,0,1] row_mask:0xf bank_mask:0xf
    buffer_load_dwordx4 v[76:79], v1, s[44:47], s10 offen nt
    s_add_u32 s10, s10, 0x7400
    v_cndmask_b32 v16, v16, v15, s[64:65]
    s_waitcnt vmcnt(4)
    v_dot2_f32_bf16 v8, v112, v4, 0
    v_dot2_f32_bf16 v9, v116, v4, 0
    v_dot2_f32_bf16 v10, v120, v4, 0
    v_dot2_f32_bf16 v11, v124, v4, 0
    v_dot2_f32_bf16 v8, v113, v5, v8
    v_dot2_f32_bf16 v9, v117, v5, v9
    v_dot2_f32_bf16 v10, v121, v5, v10
    v_dot2_f32_bf16 v11, v125, v5, v11
    v_dot2_f32_bf16 v8, v114, v6, v8
    v_dot2_f32_bf16 v9, v118, v6, v9
    v_dot2_f32_bf16 v10, v122, v6, v10
    v_dot2_f32_bf16 v11, v126, v6, v11
    v_dot2_f32_bf16 v8, v115, v7, v8
    v_dot2_f32_bf16 v9, v119, v7, v9
    v_dot2_f32_bf16 v10, v123, v7, v10
    v_dot2_f32_bf16 v11, v127, v7, v11
    v_add_f32_dpp v12, v8, v8 row_ror:8 row_mask:0xf bank_mask:0x3
    v_add_f32_dpp v12, v9, v9 row_ror:8 row_mask:0xf bank_mask:0xc
    v_add_f32_dpp v13, v10, v10 row_ror:8 row_mask:0xf bank_mask:0x3
    v_add_f32_dpp v13, v11, v11 row_ror:8 row_mask:0xf bank_mask:0xc
    buffer_load_dwordx4 v[80:83], v1, s[44:47], s10 offen nt
    s_add_u32 s10, s10, 0x400
    v_add_f32_dpp v14, v12, v12 row_half_mirror row_mask:0xf bank_mask:0x5
    v_add_f32_dpp v14, v13, v13 row_half_mirror row_mask:0xf bank_mask:0xa
    buffer_load_dwordx4 v[84:87], v1, s[44:47], s10 offen nt
    s_add_u32 s10, s10, 0x400
    v_add_f32_dpp v14, v14, v14 quad_perm:[1,0,3,2] row_mask:0xf bank_mask:0xf
    buffer_load_dwordx4 v[88:91], v1, s[44:47], s10 offen nt
    s_add_u32 s10, s10, 0x400
    v_add_f32_dpp v15, v14, v14 quad_perm:[2,3,0,1] row_mask:0xf bank_mask:0xf
    buffer_load_dwordx4 v[92:95], v1, s[44:47], s10 offen nt
    s_add_u32 s10, s10, s76
    v_cndmask_b32 v16, v16, v15, s[66:67]
    v_cvt_pk_bf16_f32 v17, v16, v16
    v_lshlrev_b32 v17, 16, v17
    v_mul_f32 v17, 0x3db504f3, v17
    v_cvt_pk_bf16_f32 v17, v17, v17
    v_lshlrev_b32 v17, 16, v17
    s_add_u32 s11, s11, 1
    v_max_f32 v3, v3, v17
    ds_read_b32 v41, v30 offset:10932
    ds_write_b32 v2, v17
    v_add_u32 v2, 64, v2
    s_memrealtime s[70:71]
    s_mov_b64 exec, 1
    ds_add_u32 v30, v40 offset:10924
    s_mov_b64 exec, -1
    s_waitcnt lgkmcnt(0)
    v_readfirstlane_b32 s71, v41
    s_sub_u32 s70, s68, s70
    s_add_u32 s70, s70, s71
    s_add_u32 s68, s68, 235
    s_cmp_gt_i32 s70, -10
    s_cselect_b32 s69, 1, 0
    s_cmp_gt_i32 s70, 60
    s_cselect_b32 s69, 2, s69
    s_cmp_eq_u32 s71, 0
    s_cselect_b32 s69, 0, s69
L_kc:
    s_cmp_eq_u32 s11, 8
    s_cbranch_scc1 L_kd
L_kn:
    s_cmp_eq_u32 s69, 0
    s_cbranch_scc1 L_k0
    s_cmp_eq_u32 s69, 1
    s_cbranch_scc1 L_k1
    s_branch L_k2
L_kd:
    ds_read_b32 v32, v29 offset:0
    ds_read_b32 v33, v29 offset:64
    ds_read_b32 v34, v29 offset:128
    ds_read_b32 v35, v29 offset:192
    ds_read_b32 v36, v29 offset:256
    ds_read_b32 v37, v29 offset:320
    ds_read_b32 v38, v29 offset:384
    ds_read_b32 v39, v29 offset:448
    s_nop 1
    v_max_f32_dpp v3, v3, v3 row_ror:8 row_mask:0xf bank_mask:0xf
    s_nop 1
    v_max_f32_dpp v3, v3, v3 row_ror:4 row_mask:0xf bank_mask:0xf
    s_nop 1
    v_max_f32_dpp v3, v3, v3 row_ror:2 row_mask:0xf bank_mask:0xf
    s_nop 1
    v_max_f32_dpp v3, v3, v3 row_ror:1 row_mask:0xf bank_mask:0xf
    v_mov_b32 v16, v3
    s_nop 1
    v_permlane16_swap_b32 v3, v16
    s_nop 1
    v_max_f32 v3, v3, v16
    v_mov_b32 v16, v3
    s_nop 1
    v_permlane32_swap_b32 v3, v16
    s_nop 1
    v_max_f32 v3, v3, v16
    s_mov_b32 s12, 0x05040100
    s_mov_b32 s13, 0x07060302
    s_waitcnt lgkmcnt(0)
    v_sub_f32 v32, v32, v3
    v_sub_f32 v33, v33, v3
    v_sub_f32 v34, v34, v3
    v_sub_f32 v35, v35, v3
    v_sub_f32 v36, v36, v3
    v_sub_f32 v37, v37, v3
    v_sub_f32 v38, v38, v3
    v_sub_f32 v39, v39, v3
    v_mul_f32 v32, 0x3fb8aa3b, v32
    v_mul_f32 v33, 0x3fb8aa3b, v33
    v_mul_f32 v34, 0x3fb8aa3b, v34
    v_mul_f32 v35, 0x3fb8aa3b, v35
    v_mul_f32 v36, 0x3fb8aa3b, v36
    v_mul_f32 v37, 0x3fb8aa3b, v37
    v_mul_f32 v38, 0x3fb8aa3b, v38
    v_mul_f32 v39, 0x3fb8aa3b, v39
    v_exp_f32 v32, v32
    v_exp_f32 v33, v33
    v_exp_f32 v34, v34
    v_exp_f32 v35, v35
    v_exp_f32 v36, v36
    v_exp_f32 v37, v37
    v_exp_f32 v38, v38
    v_exp_f32 v39, v39
    s_nop 0
    v_add_f32 v24, v32, v33
    v_add_f32 v24, v24, v34
    v_add_f32 v24, v24, v35
    v_add_f32 v24, v24, v36
    v_add_f32 v24, v24, v37
    v_add_f32 v24, v24, v38
    v_add_f32 v24, v24, v39
    v_cvt_pk_bf16_f32 v16, v32, v33
    v_lshlrev_b32 v17, 16, v16
    v_and_b32 v18, 0xffff0000, v16
    v_sub_f32 v17, v32, v17
    v_sub_f32 v18, v33, v18
    v_cvt_pk_bf16_f32 v17, v17, v18
    v_perm_b32 v32, v17, v16, s12
    v_perm_b32 v33, v17, v16, s13
    v_cvt_pk_bf16_f32 v16, v34, v35
    v_lshlrev_b32 v17, 16, v16
    v_and_b32 v18, 0xffff0000, v16
    v_sub_f32 v17, v34, v17
    v_sub_f32 v18, v35, v18
    v_cvt_pk_bf16_f32 v17, v17, v18
    v_perm_b32 v34, v17, v16, s12
    v_perm_b32 v35, v17, v16, s13
    v_cvt_pk_bf16_f32 v16, v36, v37
    v_lshlrev_b32 v17, 16, v16
    v_and_b32 v18, 0xffff0000, v16
    v_sub_f32 v17, v36, v17
    v_sub_f32 v18, v37, v18
    v_cvt_pk_bf16_f32 v17, v17, v18
    v_perm_b32 v36, v17, v16, s12
    v_perm_b32 v37, v17, v16, s13
    v_cvt_pk_bf16_f32 v16, v38, v39
    v_lshlrev_b32 v17, 16, v16
    v_and_b32 v18, 0xffff0000, v16
    v_sub_f32 v17, v38, v17
    v_sub_f32 v18, v39, v18
    v_cvt_pk_bf16_f32 v17, v17, v18
    v_perm_b32 v38, v17, v16, s12
    v_perm_b32 v39, v17, v16, s13
    ds_write_b32 v29, v32 offset:0
    ds_write_b32 v29, v33 offset:64
    ds_write_b32 v29, v34 offset:128
    ds_write_b32 v29, v35 offset:192
    ds_write_b32 v29, v36 offset:256
    ds_write_b32 v29, v37 offset:320
    ds_write_b32 v29, v38 offset:384
    ds_write_b32 v29, v39 offset:448
    v_mov_b32 v2, v28
    ds_read_b128 v[12:15], v2
    s_nop 1
    v_add_f32_dpp v24, v24, v24 row_ror:8 row_mask:0xf bank_mask:0xf
    s_nop 1
    v_add_f32_dpp v24, v24, v24 row_ror:4 row_mask:0xf bank_mask:0xf
    s_nop 1
    v_add_f32_dpp v24, v24, v24 row_ror:2 row_mask:0xf bank_mask:0xf
    s_nop 1
    v_add_f32_dpp v24, v24, v24 row_ror:1 row_mask:0xf bank_mask:0xf
    v_mov_b32 v20, v24
    s_nop 1
    v_permlane16_swap_b32 v24, v20
    s_nop 1
    v_add_f32 v24, v24, v20
    v_mov_b32 v20, v24
    s_nop 1
    v_permlane32_swap_b32 v24, v20
    s_nop 1
    v_add_f32 v24, v24, v20
    v_mov_b32 v8, 0x100
    v_mov_b32 v9, 0x302
    v_and_b32 v10, 8, v0
    v_cmp_ne_u32 vcc, 0, v10
    s_nop 1
    v_cndmask_b32 v8, v8, v9, vcc
    v_or_b32 v9, 0x0c0c0000, v8
    v_lshlrev_b32 v8, 16, v8
    v_or_b32 v8, 0x0c0c, v8
    v_and_b32 v10, 1, v0
    v_cmp_ne_u32 vcc, 0, v10
    s_nop 1
    v_cndmask_b32 v8, v9, v8, vcc
    v_mov_b32 v9, 0x0c0c0c0c
    v_bfe_u32 v10, v0, 1, 2
    v_cmp_eq_u32 vcc, 0, v10
    s_nop 1
    v_cndmask_b32 v4, v9, v8, vcc
    v_cmp_eq_u32 vcc, 1, v10
    s_nop 1
    v_cndmask_b32 v5, v9, v8, vcc
    v_cmp_eq_u32 vcc, 2, v10
    s_nop 1
    v_cndmask_b32 v6, v9, v8, vcc
    v_cmp_eq_u32 vcc, 3, v10
    s_nop 1
    v_cndmask_b32 v7, v9, v8, vcc
    v_mov_b32 v25, v24
    v_mov_b32 v24, v3
    s_lshl_b32 s12, s3, 3
    v_mov_b32 v26, s12
    s_mov_b64 exec, 1
    ds_write_b64 v26, v[24:25] offset:10880
    s_mov_b64 exec, -1
    v_mov_b32 v27, 1
    s_mov_b64 exec, 1
    ds_add_u32 v30, v27 offset:10912
    s_mov_b64 exec, -1
    v_mov_b32 v20, 0
    v_mov_b32 v21, 0
    v_mov_b32 v22, 0
    v_mov_b32 v23, 0
    s_mov_b32 s11, 0
    v_bfe_u32 v26, v0, 2, 2
    v_lshlrev_b32 v27, 6, v26
    v_and_b32 v26, 1, v0
    v_lshl_add_u32 v27, v26, 4, v27
    v_bfe_u32 v26, v0, 4, 1
    v_lshl_add_u32 v27, v26, 3, v27
    v_bfe_u32 v26, v0, 1, 1
    v_lshl_add_u32 v27, v26, 5, v27
    v_lshrrev_b32 v26, 5, v0
    s_mul_i32 s12, s3, 544
    s_add_u32 s12, s12, 8704
    v_lshl_add_u32 v28, v26, 2, v27
    v_add_u32 v28, s12, v28
    s_mov_b32 s68, 1054
    s_branch L_vAn
L_vBn:
    s_cmp_eq_u32 s69, 0
    s_cbranch_scc1 L_vB0
    s_cmp_eq_u32 s69, 1
    s_cbranch_scc1 L_vB1
L_vB2:
    s_waitcnt lgkmcnt(0)
    ds_read_b128 v[16:19], v2 offset:48
    v_perm_b32 v8, v12, v12, v4
    v_perm_b32 v9, v12, v12, v5
    v_perm_b32 v10, v12, v12, v6
    v_perm_b32 v11, v12, v12, v7
    s_waitcnt vmcnt(3)
    s_nop 0
    v_mfma_f32_16x16x32_bf16 v[20:23], v[8:11], v[96:99], v[20:23]
    buffer_load_dwordx4 v[64:67], v1, s[44:47], s10 offen nt
    s_add_u32 s10, s10, 0x400
    v_perm_b32 v8, v13, v13, v4
    v_perm_b32 v9, v13, v13, v5
    v_perm_b32 v10, v13, v13, v6
    v_perm_b32 v11, v13, v13, v7
    s_waitcnt vmcnt(3)
    s_nop 0
    v_mfma_f32_16x16x32_bf16 v[20:23], v[8:11], v[100:103], v[20:23]
    buffer_load_dwordx4 v[68:71], v1, s[44:47], s10 offen nt
    s_add_u32 s10, s10, 0x400
    v_perm_b32 v8, v14, v14, v4
    v_perm_b32 v9, v14, v14, v5
    v_perm_b32 v10, v14, v14, v6
    v_perm_b32 v11, v14, v14, v7
    s_waitcnt vmcnt(3)
    s_nop 0
    v_mfma_f32_16x16x32_bf16 v[20:23], v[8:11], v[104:107], v[20:23]
    buffer_load_dwordx4 v[72:75], v1, s[44:47], s10 offen nt
    s_add_u32 s10, s10, 0x400
    v_perm_b32 v8, v15, v15, v4
    v_perm_b32 v9, v15, v15, v5
    v_perm_b32 v10, v15, v15, v6
    v_perm_b32 v11, v15, v15, v7
    s_waitcnt vmcnt(3)
    s_nop 0
    v_mfma_f32_16x16x32_bf16 v[20:23], v[8:11], v[108:111], v[20:23]
    buffer_load_dwordx4 v[76:79], v1, s[44:47], s10 offen nt
    s_add_u32 s10, s10, 0x7400
    s_waitcnt lgkmcnt(0)
    ds_read_b128 v[12:15], v2 offset:64
    ds_read_b32 v41, v30 offset:10932
    v_perm_b32 v8, v16, v16, v4
    v_perm_b32 v9, v16, v16, v5
    v_perm_b32 v10, v16, v16, v6
    v_perm_b32 v11, v16, v16, v7
    s_waitcnt vmcnt(3)
    s_nop 0
    v_mfma_f32_16x16x32_bf16 v[20:23], v[8:11], v[112:115], v[20:23]
    buffer_load_dwordx4 v[80:83], v1, s[44:47], s10 offen nt
    s_add_u32 s10, s10, 0x400
    v_perm_b32 v8, v17, v17, v4
    v_perm_b32 v9, v17, v17, v5
    v_perm_b32 v10, v17, v17, v6
    v_perm_b32 v11, v17, v17, v7
    s_waitcnt vmcnt(3)
    s_nop 0
    v_mfma_f32_16x16x32_bf16 v[20:23], v[8:11], v[116:119], v[20:23]
    buffer_load_dwordx4 v[84:87], v1, s[44:47], s10 offen nt
    s_add_u32 s10, s10, 0x400
    v_perm_b32 v8, v18, v18, v4
    v_perm_b32 v9, v18, v18, v5
    v_perm_b32 v10, v18, v18, v6
    v_perm_b32 v11, v18, v18, v7
    s_waitcnt vmcnt(3)
    s_nop 0
    v_mfma_f32_16x16x32_bf16 v[20:23], v[8:11], v[120:123], v[20:23]
    buffer_load_dwordx4 v[88:91], v1, s[44:47], s10 offen nt
    s_add_u32 s10, s10, 0x400
    v_perm_b32 v8, v19, v19, v4
    v_perm_b32 v9, v19, v19, v5
    v_perm_b32 v10, v19, v19, v6
    v_perm_b32 v11, v19, v19, v7
    s_waitcnt vmcnt(3)
    s_nop 0
    v_mfma_f32_16x16x32_bf16 v[20:23], v[8:11], v[124:127], v[20:23]
    buffer_load_dwordx4 v[92:95], v1, s[44:47], s10 offen nt
    s_add_u32 s10, s10, s76
    s_add_u32 s11, s11, 1
    s_cmp_eq_u32 s11, 8
    s_cbranch_scc1 L_vd
    v_add_u32 v2, 64, v2
    s_memrealtime s[70:71]
    s_mov_b64 exec, 1
    ds_add_u32 v30, v40 offset:10924
    s_mov_b64 exec, -1
    s_waitcnt lgkmcnt(0)
    v_readfirstlane_b32 s71, v41
    s_sub_u32 s70, s68, s70
    s_add_u32 s70, s70, s71
    s_add_u32 s68, s68, 114
    s_cmp_gt_i32 s70, -10
    s_cselect_b32 s69, 1, 0
    s_cmp_gt_i32 s70, 50
    s_cselect_b32 s69, 2, s69
    s_cmp_eq_u32 s71, 0
    s_cselect_b32 s69, 0, s69
    s_branch L_vAn
L_vB1:
    s_waitcnt lgkmcnt(0)
    ds_read_b128 v[16:19], v2 offset:48
    v_perm_b32 v8, v12, v12, v4
    v_perm_b32 v9, v12, v12, v5
    v_perm_b32 v10, v12, v12, v6
    v_perm_b32 v11, v12, v12, v7
    s_waitcnt vmcnt(5)
    s_nop 0
    v_mfma_f32_16x16x32_bf16 v[20:23], v[8:11], v[96:99], v[20:23]
    buffer_load_dwordx4 v[64:67], v1, s[44:47], s10 offen nt
    s_add_u32 s10, s10, 0x400
    v_perm_b32 v8, v13, v13, v4
    v_perm_b32 v9, v13, v13, v5
    v_perm_b32 v10, v13, v13, v6
    v_perm_b32 v11, v13, v13, v7
    s_waitcnt vmcnt(5)
    s_nop 0
    v_mfma_f32_16x16x32_bf16 v[20:23], v[8:11], v[100:103], v[20:23]
    buffer_load_dwordx4 v[68:71], v1, s[44:47], s10 offen nt
    s_add_u32 s10, s10, 0x400
    v_perm_b32 v8, v14, v14, v4
    v_perm_b32 v9, v14, v14, v5
    v_perm_b32 v10, v14, v14, v6
    v_perm_b32 v11, v14, v14, v7
    s_waitcnt vmcnt(5)
    s_nop 0
    v_mfma_f32_16x16x32_bf16 v[20:23], v[8:11], v[104:107], v[20:23]
    buffer_load_dwordx4 v[72:75], v1, s[44:47], s10 offen nt
    s_add_u32 s10, s10, 0x400
    v_perm_b32 v8, v15, v15, v4
    v_perm_b32 v9, v15, v15, v5
    v_perm_b32 v10, v15, v15, v6
    v_perm_b32 v11, v15, v15, v7
    s_waitcnt vmcnt(5)
    s_nop 0
    v_mfma_f32_16x16x32_bf16 v[20:23], v[8:11], v[108:111], v[20:23]
    buffer_load_dwordx4 v[76:79], v1, s[44:47], s10 offen nt
    s_add_u32 s10, s10, 0x7400
    s_waitcnt lgkmcnt(0)
    ds_read_b128 v[12:15], v2 offset:64
    ds_read_b32 v41, v30 offset:10932
    v_perm_b32 v8, v16, v16, v4
    v_perm_b32 v9, v16, v16, v5
    v_perm_b32 v10, v16, v16, v6
    v_perm_b32 v11, v16, v16, v7
    s_waitcnt vmcnt(5)
    s_nop 0
    v_mfma_f32_16x16x32_bf16 v[20:23], v[8:11], v[112:115], v[20:23]
    buffer_load_dwordx4 v[80:83], v1, s[44:47], s10 offen nt
    s_add_u32 s10, s10, 0x400
    v_perm_b32 v8, v17, v17, v4
    v_perm_b32 v9, v17, v17, v5
    v_perm_b32 v10, v17, v17, v6
    v_perm_b32 v11, v17, v17, v7
    s_waitcnt vmcnt(5)
    s_nop 0
    v_mfma_f32_16x16x32_bf16 v[20:23], v[8:11], v[116:119], v[20:23]
    buffer_load_dwordx4 v[84:87], v1, s[44:47], s10 offen nt
    s_add_u32 s10, s10, 0x400
    v_perm_b32 v8, v18, v18, v4
    v_perm_b32 v9, v18, v18, v5
    v_perm_b32 v10, v18, v18, v6
    v_perm_b32 v11, v18, v18, v7
    s_waitcnt vmcnt(5)
    s_nop 0
    v_mfma_f32_16x16x32_bf16 v[20:23], v[8:11], v[120:123], v[20:23]
    buffer_load_dwordx4 v[88:91], v1, s[44:47], s10 offen nt
    s_add_u32 s10, s10, 0x400
    v_perm_b32 v8, v19, v19, v4
    v_perm_b32 v9, v19, v19, v5
    v_perm_b32 v10, v19, v19, v6
    v_perm_b32 v11, v19, v19, v7
    s_waitcnt vmcnt(5)
    s_nop 0
    v_mfma_f32_16x16x32_bf16 v[20:23], v[8:11], v[124:127], v[20:23]
    buffer_load_dwordx4 v[92:95], v1, s[44:47], s10 offen nt
    s_add_u32 s10, s10, s76
    s_add_u32 s11, s11, 1
    s_cmp_eq_u32 s11, 8
    s_cbranch_scc1 L_vd
    v_add_u32 v2, 64, v2
    s_memrealtime s[70:71]
    s_mov_b64 exec, 1
    ds_add_u32 v30, v40 offset:10924
    s_mov_b64 exec, -1
    s_waitcnt lgkmcnt(0)
    v_readfirstlane_b32 s71, v41
    s_sub_u32 s70, s68, s70
    s_add_u32 s70, s70, s71
    s_add_u32 s68, s68, 114
    s_cmp_gt_i32 s70, -10
    s_cselect_b32 s69, 1, 0
    s_cmp_gt_i32 s70, 50
    s_cselect_b32 s69, 2, s69
    s_cmp_eq_u32 s71, 0
    s_cselect_b32 s69, 0, s69
    s_branch L_vAn
L_vB0:
    s_waitcnt lgkmcnt(0)
    ds_read_b128 v[16:19], v2 offset:48
    v_perm_b32 v8, v12, v12, v4
    v_perm_b32 v9, v12, v12, v5
    v_perm_b32 v10, v12, v12, v6
    v_perm_b32 v11, v12, v12, v7
    s_waitcnt vmcnt(7)
    s_nop 0
    v_mfma_f32_16x16x32_bf16 v[20:23], v[8:11], v[96:99], v[20:23]
    buffer_load_dwordx4 v[64:67], v1, s[44:47], s10 offen nt
    s_add_u32 s10, s10, 0x400
    v_perm_b32 v8, v13, v13, v4
    v_perm_b32 v9, v13, v13, v5
    v_perm_b32 v10, v13, v13, v6
    v_perm_b32 v11, v13, v13, v7
    s_waitcnt vmcnt(7)
    s_nop 0
    v_mfma_f32_16x16x32_bf16 v[20:23], v[8:11], v[100:103], v[20:23]
    buffer_load_dwordx4 v[68:71], v1, s[44:47], s10 offen nt
    s_add_u32 s10, s10, 0x400
    v_perm_b32 v8, v14, v14, v4
    v_perm_b32 v9, v14, v14, v5
    v_perm_b32 v10, v14, v14, v6
    v_perm_b32 v11, v14, v14, v7
    s_waitcnt vmcnt(7)
    s_nop 0
    v_mfma_f32_16x16x32_bf16 v[20:23], v[8:11], v[104:107], v[20:23]
    buffer_load_dwordx4 v[72:75], v1, s[44:47], s10 offen nt
    s_add_u32 s10, s10, 0x400
    v_perm_b32 v8, v15, v15, v4
    v_perm_b32 v9, v15, v15, v5
    v_perm_b32 v10, v15, v15, v6
    v_perm_b32 v11, v15, v15, v7
    s_waitcnt vmcnt(7)
    s_nop 0
    v_mfma_f32_16x16x32_bf16 v[20:23], v[8:11], v[108:111], v[20:23]
    buffer_load_dwordx4 v[76:79], v1, s[44:47], s10 offen nt
    s_add_u32 s10, s10, 0x7400
    s_waitcnt lgkmcnt(0)
    ds_read_b128 v[12:15], v2 offset:64
    ds_read_b32 v41, v30 offset:10932
    v_perm_b32 v8, v16, v16, v4
    v_perm_b32 v9, v16, v16, v5
    v_perm_b32 v10, v16, v16, v6
    v_perm_b32 v11, v16, v16, v7
    s_waitcnt vmcnt(7)
    s_nop 0
    v_mfma_f32_16x16x32_bf16 v[20:23], v[8:11], v[112:115], v[20:23]
    buffer_load_dwordx4 v[80:83], v1, s[44:47], s10 offen nt
    s_add_u32 s10, s10, 0x400
    v_perm_b32 v8, v17, v17, v4
    v_perm_b32 v9, v17, v17, v5
    v_perm_b32 v10, v17, v17, v6
    v_perm_b32 v11, v17, v17, v7
    s_waitcnt vmcnt(7)
    s_nop 0
    v_mfma_f32_16x16x32_bf16 v[20:23], v[8:11], v[116:119], v[20:23]
    buffer_load_dwordx4 v[84:87], v1, s[44:47], s10 offen nt
    s_add_u32 s10, s10, 0x400
    v_perm_b32 v8, v18, v18, v4
    v_perm_b32 v9, v18, v18, v5
    v_perm_b32 v10, v18, v18, v6
    v_perm_b32 v11, v18, v18, v7
    s_waitcnt vmcnt(7)
    s_nop 0
    v_mfma_f32_16x16x32_bf16 v[20:23], v[8:11], v[120:123], v[20:23]
    buffer_load_dwordx4 v[88:91], v1, s[44:47], s10 offen nt
    s_add_u32 s10, s10, 0x400
    v_perm_b32 v8, v19, v19, v4
    v_perm_b32 v9, v19, v19, v5
    v_perm_b32 v10, v19, v19, v6
    v_perm_b32 v11, v19, v19, v7
    s_waitcnt vmcnt(7)
    s_nop 0
    v_mfma_f32_16x16x32_bf16 v[20:23], v[8:11], v[124:127], v[20:23]
    buffer_load_dwordx4 v[92:95], v1, s[44:47], s10 offen nt
    s_add_u32 s10, s10, s76
    s_add_u32 s11, s11, 1
    s_cmp_eq_u32 s11, 8
    s_cbranch_scc1 L_vd
    v_add_u32 v2, 64, v2
    s_memrealtime s[70:71]
    s_mov_b64 exec, 1
    ds_add_u32 v30, v40 offset:10924
    s_mov_b64 exec, -1
    s_waitcnt lgkmcnt(0)
    v_readfirstlane_b32 s71, v41
    s_sub_u32 s70, s68, s70
    s_add_u32 s70, s70, s71
    s_add_u32 s68, s68, 114
    s_cmp_gt_i32 s70, -10
    s_cselect_b32 s69, 1, 0
    s_cmp_gt_i32 s70, 50
    s_cselect_b32 s69, 2, s69
    s_cmp_eq_u32 s71, 0
    s_cselect_b32 s69, 0, s69
L_vAn:
    s_cmp_eq_u32 s69, 0
    s_cbranch_scc1 L_vA0
    s_cmp_eq_u32 s69, 1
    s_cbranch_scc1 L_vA1
L_vA2:
    s_waitcnt lgkmcnt(0)
    ds_read_b128 v[16:19], v2 offset:16
    v_perm_b32 v8, v12, v12, v4
    v_perm_b32 v9, v12, v12, v5
    v_perm_b32 v10, v12, v12, v6
    v_perm_b32 v11, v12, v12, v7
    s_waitcnt vmcnt(3)
    s_nop 0
    v_mfma_f32_16x16x32_bf16 v[20:23], v[8:11], v[64:67], v[20:23]
    buffer_load_dwordx4 v[96:99], v1, s[44:47], s10 offen nt
    s_add_u32 s10, s10, 0x400
    v_perm_b32 v8, v13, v13, v4
    v_perm_b32 v9, v13, v13, v5
    v_perm_b32 v10, v13, v13, v6
    v_perm_b32 v11, v13, v13, v7
    s_waitcnt vmcnt(3)
    s_nop 0
    v_mfma_f32_16x16x32_bf16 v[20:23], v[8:11], v[68:71], v[20:23]
    buffer_load_dwordx4 v[100:103], v1, s[44:47], s10 offen nt
    s_add_u32 s10, s10, 0x400
    v_perm_b32 v8, v14, v14, v4
    v_perm_b32 v9, v14, v14, v5
    v_perm_b32 v10, v14, v14, v6
    v_perm_b32 v11, v14, v14, v7
    s_waitcnt vmcnt(3)
    s_nop 0
    v_mfma_f32_16x16x32_bf16 v[20:23], v[8:11], v[72:75], v[20:23]
    buffer_load_dwordx4 v[104:107], v1, s[44:47], s10 offen nt
    s_add_u32 s10, s10, 0x400
    v_perm_b32 v8, v15, v15, v4
    v_perm_b32 v9, v15, v15, v5
    v_perm_b32 v10, v15, v15, v6
    v_perm_b32 v11, v15, v15, v7
    s_waitcnt vmcnt(3)
    s_nop 0
    v_mfma_f32_16x16x32_bf16 v[20:23], v[8:11], v[76:79], v[20:23]
    buffer_load_dwordx4 v[108:111], v1, s[44:47], s10 offen nt
    s_add_u32 s10, s10, 0x7400
    s_waitcnt lgkmcnt(0)
    ds_read_b128 v[12:15], v2 offset:32
    ds_read_b32 v41, v30 offset:10932
    v_perm_b32 v8, v16, v16, v4
    v_perm_b32 v9, v16, v16, v5
    v_perm_b32 v10, v16, v16, v6
    v_perm_b32 v11, v16, v16, v7
    s_waitcnt vmcnt(3)
    s_nop 0
    v_mfma_f32_16x16x32_bf16 v[20:23], v[8:11], v[80:83], v[20:23]
    buffer_load_dwordx4 v[112:115], v1, s[44:47], s10 offen nt
    s_add_u32 s10, s10, 0x400
    v_perm_b32 v8, v17, v17, v4
    v_perm_b32 v9, v17, v17, v5
    v_perm_b32 v10, v17, v17, v6
    v_perm_b32 v11, v17, v17, v7
    s_waitcnt vmcnt(3)
    s_nop 0
    v_mfma_f32_16x16x32_bf16 v[20:23], v[8:11], v[84:87], v[20:23]
    buffer_load_dwordx4 v[116:119], v1, s[44:47], s10 offen nt
    s_add_u32 s10, s10, 0x400
    v_perm_b32 v8, v18, v18, v4
    v_perm_b32 v9, v18, v18, v5
    v_perm_b32 v10, v18, v18, v6
    v_perm_b32 v11, v18, v18, v7
    s_waitcnt vmcnt(3)
    s_nop 0
    v_mfma_f32_16x16x32_bf16 v[20:23], v[8:11], v[88:91], v[20:23]
    buffer_load_dwordx4 v[120:123], v1, s[44:47], s10 offen nt
    s_add_u32 s10, s10, 0x400
    v_perm_b32 v8, v19, v19, v4
    v_perm_b32 v9, v19, v19, v5
    v_perm_b32 v10, v19, v19, v6
    v_perm_b32 v11, v19, v19, v7
    s_waitcnt vmcnt(3)
    s_nop 0
    v_mfma_f32_16x16x32_bf16 v[20:23], v[8:11], v[92:95], v[20:23]
    buffer_load_dwordx4 v[124:127], v1, s[44:47], s10 offen nt
    s_add_u32 s10, s10, s77
    s_memrealtime s[70:71]
    s_waitcnt lgkmcnt(0)
    v_readfirstlane_b32 s71, v41
    s_sub_u32 s70, s68, s70
    s_add_u32 s70, s70, s71
    s_add_u32 s68, s68, 115
    s_cmp_gt_i32 s70, -10
    s_cselect_b32 s69, 1, 0
    s_cmp_gt_i32 s70, 50
    s_cselect_b32 s69, 2, s69
    s_cmp_eq_u32 s71, 0
    s_cselect_b32 s69, 0, s69
    s_branch L_vBn
L_vA1:
    s_waitcnt lgkmcnt(0)
    ds_read_b128 v[16:19], v2 offset:16
    v_perm_b32 v8, v12, v12, v4
    v_perm_b32 v9, v12, v12, v5
    v_perm_b32 v10, v12, v12, v6
    v_perm_b32 v11, v12, v12, v7
    s_waitcnt vmcnt(5)
    s_nop 0
    v_mfma_f32_16x16x32_bf16 v[20:23], v[8:11], v[64:67], v[20:23]
    buffer_load_dwordx4 v[96:99], v1, s[44:47], s10 offen nt
    s_add_u32 s10, s10, 0x400
    v_perm_b32 v8, v13, v13, v4
    v_perm_b32 v9, v13, v13, v5
    v_perm_b32 v10, v13, v13, v6
    v_perm_b32 v11, v13, v13, v7
    s_waitcnt vmcnt(5)
    s_nop 0
    v_mfma_f32_16x16x32_bf16 v[20:23], v[8:11], v[68:71], v[20:23]
    buffer_load_dwordx4 v[100:103], v1, s[44:47], s10 offen nt
    s_add_u32 s10, s10, 0x400
    v_perm_b32 v8, v14, v14, v4
    v_perm_b32 v9, v14, v14, v5
    v_perm_b32 v10, v14, v14, v6
    v_perm_b32 v11, v14, v14, v7
    s_waitcnt vmcnt(5)
    s_nop 0
    v_mfma_f32_16x16x32_bf16 v[20:23], v[8:11], v[72:75], v[20:23]
    buffer_load_dwordx4 v[104:107], v1, s[44:47], s10 offen nt
    s_add_u32 s10, s10, 0x400
    v_perm_b32 v8, v15, v15, v4
    v_perm_b32 v9, v15, v15, v5
    v_perm_b32 v10, v15, v15, v6
    v_perm_b32 v11, v15, v15, v7
    s_waitcnt vmcnt(5)
    s_nop 0
    v_mfma_f32_16x16x32_bf16 v[20:23], v[8:11], v[76:79], v[20:23]
    buffer_load_dwordx4 v[108:111], v1, s[44:47], s10 offen nt
    s_add_u32 s10, s10, 0x7400
    s_waitcnt lgkmcnt(0)
    ds_read_b128 v[12:15], v2 offset:32
    ds_read_b32 v41, v30 offset:10932
    v_perm_b32 v8, v16, v16, v4
    v_perm_b32 v9, v16, v16, v5
    v_perm_b32 v10, v16, v16, v6
    v_perm_b32 v11, v16, v16, v7
    s_waitcnt vmcnt(5)
    s_nop 0
    v_mfma_f32_16x16x32_bf16 v[20:23], v[8:11], v[80:83], v[20:23]
    buffer_load_dwordx4 v[112:115], v1, s[44:47], s10 offen nt
    s_add_u32 s10, s10, 0x400
    v_perm_b32 v8, v17, v17, v4
    v_perm_b32 v9, v17, v17, v5
    v_perm_b32 v10, v17, v17, v6
    v_perm_b32 v11, v17, v17, v7
    s_waitcnt vmcnt(5)
    s_nop 0
    v_mfma_f32_16x16x32_bf16 v[20:23], v[8:11], v[84:87], v[20:23]
    buffer_load_dwordx4 v[116:119], v1, s[44:47], s10 offen nt
    s_add_u32 s10, s10, 0x400
    v_perm_b32 v8, v18, v18, v4
    v_perm_b32 v9, v18, v18, v5
    v_perm_b32 v10, v18, v18, v6
    v_perm_b32 v11, v18, v18, v7
    s_waitcnt vmcnt(5)
    s_nop 0
    v_mfma_f32_16x16x32_bf16 v[20:23], v[8:11], v[88:91], v[20:23]
    buffer_load_dwordx4 v[120:123], v1, s[44:47], s10 offen nt
    s_add_u32 s10, s10, 0x400
    v_perm_b32 v8, v19, v19, v4
    v_perm_b32 v9, v19, v19, v5
    v_perm_b32 v10, v19, v19, v6
    v_perm_b32 v11, v19, v19, v7
    s_waitcnt vmcnt(5)
    s_nop 0
    v_mfma_f32_16x16x32_bf16 v[20:23], v[8:11], v[92:95], v[20:23]
    buffer_load_dwordx4 v[124:127], v1, s[44:47], s10 offen nt
    s_add_u32 s10, s10, s77
    s_memrealtime s[70:71]
    s_waitcnt lgkmcnt(0)
    v_readfirstlane_b32 s71, v41
    s_sub_u32 s70, s68, s70
    s_add_u32 s70, s70, s71
    s_add_u32 s68, s68, 115
    s_cmp_gt_i32 s70, -10
    s_cselect_b32 s69, 1, 0
    s_cmp_gt_i32 s70, 50
    s_cselect_b32 s69, 2, s69
    s_cmp_eq_u32 s71, 0
    s_cselect_b32 s69, 0, s69
    s_branch L_vBn
L_vA0:
    s_waitcnt lgkmcnt(0)
    ds_read_b128 v[16:19], v2 offset:16
    v_perm_b32 v8, v12, v12, v4
    v_perm_b32 v9, v12, v12, v5
    v_perm_b32 v10, v12, v12, v6
    v_perm_b32 v11, v12, v12, v7
    s_waitcnt vmcnt(7)
    s_nop 0
    v_mfma_f32_16x16x32_bf16 v[20:23], v[8:11], v[64:67], v[20:23]
    buffer_load_dwordx4 v[96:99], v1, s[44:47], s10 offen nt
    s_add_u32 s10, s10, 0x400
    v_perm_b32 v8, v13, v13, v4
    v_perm_b32 v9, v13, v13, v5
    v_perm_b32 v10, v13, v13, v6
    v_perm_b32 v11, v13, v13, v7
    s_waitcnt vmcnt(7)
    s_nop 0
    v_mfma_f32_16x16x32_bf16 v[20:23], v[8:11], v[68:71], v[20:23]
    buffer_load_dwordx4 v[100:103], v1, s[44:47], s10 offen nt
    s_add_u32 s10, s10, 0x400
    v_perm_b32 v8, v14, v14, v4
    v_perm_b32 v9, v14, v14, v5
    v_perm_b32 v10, v14, v14, v6
    v_perm_b32 v11, v14, v14, v7
    s_waitcnt vmcnt(7)
    s_nop 0
    v_mfma_f32_16x16x32_bf16 v[20:23], v[8:11], v[72:75], v[20:23]
    buffer_load_dwordx4 v[104:107], v1, s[44:47], s10 offen nt
    s_add_u32 s10, s10, 0x400
    v_perm_b32 v8, v15, v15, v4
    v_perm_b32 v9, v15, v15, v5
    v_perm_b32 v10, v15, v15, v6
    v_perm_b32 v11, v15, v15, v7
    s_waitcnt vmcnt(7)
    s_nop 0
    v_mfma_f32_16x16x32_bf16 v[20:23], v[8:11], v[76:79], v[20:23]
    buffer_load_dwordx4 v[108:111], v1, s[44:47], s10 offen nt
    s_add_u32 s10, s10, 0x7400
    s_waitcnt lgkmcnt(0)
    ds_read_b128 v[12:15], v2 offset:32
    ds_read_b32 v41, v30 offset:10932
    v_perm_b32 v8, v16, v16, v4
    v_perm_b32 v9, v16, v16, v5
    v_perm_b32 v10, v16, v16, v6
    v_perm_b32 v11, v16, v16, v7
    s_waitcnt vmcnt(7)
    s_nop 0
    v_mfma_f32_16x16x32_bf16 v[20:23], v[8:11], v[80:83], v[20:23]
    buffer_load_dwordx4 v[112:115], v1, s[44:47], s10 offen nt
    s_add_u32 s10, s10, 0x400
    v_perm_b32 v8, v17, v17, v4
    v_perm_b32 v9, v17, v17, v5
    v_perm_b32 v10, v17, v17, v6
    v_perm_b32 v11, v17, v17, v7
    s_waitcnt vmcnt(7)
    s_nop 0
    v_mfma_f32_16x16x32_bf16 v[20:23], v[8:11], v[84:87], v[20:23]
    buffer_load_dwordx4 v[116:119], v1, s[44:47], s10 offen nt
    s_add_u32 s10, s10, 0x400
    v_perm_b32 v8, v18, v18, v4
    v_perm_b32 v9, v18, v18, v5
    v_perm_b32 v10, v18, v18, v6
    v_perm_b32 v11, v18, v18, v7
    s_waitcnt vmcnt(7)
    s_nop 0
    v_mfma_f32_16x16x32_bf16 v[20:23], v[8:11], v[88:91], v[20:23]
    buffer_load_dwordx4 v[120:123], v1, s[44:47], s10 offen nt
    s_add_u32 s10, s10, 0x400
    v_perm_b32 v8, v19, v19, v4
    v_perm_b32 v9, v19, v19, v5
    v_perm_b32 v10, v19, v19, v6
    v_perm_b32 v11, v19, v19, v7
    s_waitcnt vmcnt(7)
    s_nop 0
    v_mfma_f32_16x16x32_bf16 v[20:23], v[8:11], v[92:95], v[20:23]
    buffer_load_dwordx4 v[124:127], v1, s[44:47], s10 offen nt
    s_add_u32 s10, s10, s77
    s_memrealtime s[70:71]
    s_waitcnt lgkmcnt(0)
    v_readfirstlane_b32 s71, v41
    s_sub_u32 s70, s68, s70
    s_add_u32 s70, s70, s71
    s_add_u32 s68, s68, 115
    s_cmp_gt_i32 s70, -10
    s_cselect_b32 s69, 1, 0
    s_cmp_gt_i32 s70, 50
    s_cselect_b32 s69, 2, s69
    s_cmp_eq_u32 s71, 0
    s_cselect_b32 s69, 0, s69
    s_branch L_vBn
L_vd:
L_send:
    s_nop 4
    v_permlane32_swap_b32 v20, v22
    v_permlane32_swap_b32 v21, v23
    s_nop 0
    v_add_f32 v20, v20, v22
    v_add_f32 v21, v21, v23
    v_cvt_pk_bf16_f32 v12, v20, v21
    ds_write_b32 v28, v12
    v_lshlrev_b32 v13, 16, v12
    v_and_b32 v14, 0xffff0000, v12
    v_sub_f32 v13, v20, v13
    v_sub_f32 v14, v21, v14
    v_cvt_pk_bf16_f32 v13, v13, v14
    ds_write_b32 v28, v13 offset:272
    s_waitcnt lgkmcnt(0)
    s_barrier
    s_endpgm
L_helper:
    s_setprio 3
    s_memrealtime s[4:5]
    s_sub_u32 s3, s3, 4
    s_lshl_b32 s74, s7, 1
    s_add_u32 s74, s74, s8
    v_lshrrev_b32 v24, 4, v0
    v_and_b32 v25, 15, v0
    s_lshl_b32 s12, s3, 6
    v_add_u32 v1, s12, v0
    v_lshlrev_b32 v2, 4, v0
    v_mov_b32 v95, 0
    v_mov_b32 v93, 0x3ff
    s_cmp_ge_u32 s3, 2
    s_cbranch_scc1 L_h23
    s_and_b32 s73, s2, 7
    s_lshr_b32 s75, s2, 3
    s_mul_i32 s12, s73, 7
    s_lshr_b32 s13, s75, 2
    s_add_u32 s12, s12, s13
    s_cmp_lt_u32 s75, 28
    s_cselect_b32 s15, s12, 99
    s_cmp_ge_u32 s12, 27
    s_cselect_b32 s13, 27, 0
    s_cselect_b32 s14, 1, 0
    s_sub_u32 s12, s12, s13
    s_lshl_b32 s12, s12, 1
    s_and_b32 s13, s75, 1
    s_add_u32 s12, s12, s13
    s_bfe_u32 s11, s75, 0x10001
    s_lshl_b32 s69, s12, 6
    s_lshl_b32 s12, s12, 9
    s_mul_i32 s70, s14, 55296
    s_add_u32 s70, s70, s12
    s_mul_i32 s12, s11, 27648
    s_add_u32 s70, s70, s12
    s_add_u32 s70, s70, 0xf0000
    s_lshl_b32 s12, s6, 2
    s_and_b32 s13, s74, 3
    s_add_u32 s12, s12, s13
    s_lshl_b32 s13, s12, 6
    s_lshl_b32 s73, s6, 12
    s_lshl_b32 s75, s74, 9
    s_add_u32 s73, s73, s75
    s_add_u32 s73, s73, 0xd0000
    s_lshr_b32 s75, s74, 2
    s_cmp_eq_u32 s3, 0
    s_cselect_b32 s69, s13, s69
    s_cselect_b32 s70, s73, s70
    s_cselect_b32 s15, 0, s15
    s_cselect_b32 s11, s75, s11
    s_mul_i32 s68, s3, 4736
    s_sub_u32 s68, 8192, s68
    s_mul_i32 s73, s3, 25600
    s_add_u32 s75, s73, 33280
    s_add_u32 s73, s73, 12800
    s_mul_i32 s12, s11, 320
    s_mul_i32 s12, s12, s68
    s_add_u32 s69, s69, s12
    v_lshrrev_b32 v26, 2, v0
    v_mul_u32_u24 v26, s68, v26
    v_and_b32 v27, 3, v0
    v_lshl_add_u32 v26, v27, 4, v26
    v_add_u32 v26, s69, v26
    s_mul_i32 s50, s68, 640
    s_mov_b32 s51, 0x00020000
    s_lshl_b32 s68, s68, 4
    s_cmp_ge_u32 s15, 54
    s_cbranch_scc1 L_hb1
    s_waitcnt lgkmcnt(0)
    s_mov_b32 s60, s16
    s_mov_b32 s61, s17
    s_mov_b32 s62, 0x1400
    s_mov_b32 s63, 0x00020000
    s_mov_b32 s56, s38
    s_mov_b32 s57, s39
    s_mov_b32 s58, 0x100
    s_mov_b32 s59, 0x00020000
    s_cmp_lg_u32 s14, 0
    s_cselect_b32 s48, s30, s28
    s_cselect_b32 s49, s31, s29
    s_cmp_lg_u32 s3, 0
    s_cbranch_scc1 L_h1a
    s_mov_b32 s48, s22
    s_mov_b32 s49, s23
    s_or_b32 s4, s4, 1
    s_cmp_lg_u32 s2, 0
    s_cbranch_scc1 L_h1a
    v_mov_b32 v60, s4
    v_lshlrev_b32 v61, 7, v0
    s_mov_b64 exec, 3
    buffer_store_dword v60, v61, s[56:59], 0 offen sc1
    s_mov_b64 exec, -1
L_h1a:
    s_mov_b32 m0, s75
    s_mov_b32 s10, 0
    buffer_load_dwordx4 v2, s[60:63], 0 offen offset:0 lds
    buffer_load_dwordx4 v2, s[60:63], 0 offen offset:1024 lds
    buffer_load_dwordx4 v2, s[60:63], 0 offen offset:2048 lds
    buffer_load_dwordx4 v2, s[60:63], 0 offen offset:3072 lds
    s_add_u32 m0, s75, 0x1000
    s_mov_b32 s13, 0x1000
    buffer_load_dwordx4 v2, s[60:63], s13 offen lds
    s_mov_b32 m0, s73
    s_nop 0
    buffer_load_dwordx4 v26, s[48:51], s10 offen nt lds
    s_add_u32 m0, m0, 0x400
    s_add_u32 s10, s10, s68
    buffer_load_dwordx4 v26, s[48:51], s10 offen nt lds
    s_add_u32 m0, m0, 0x400
    s_add_u32 s10, s10, s68
    buffer_load_dwordx4 v26, s[48:51], s10 offen nt lds
    s_add_u32 m0, m0, 0x400
    s_add_u32 s10, s10, s68
    buffer_load_dwordx4 v26, s[48:51], s10 offen nt lds
    s_add_u32 m0, m0, 0x400
    s_add_u32 s10, s10, s68
    buffer_load_dwordx4 v26, s[48:51], s10 offen nt lds
    s_add_u32 m0, m0, 0x400
    s_add_u32 s10, s10, s68
    buffer_load_dwordx4 v26, s[48:51], s10 offen nt lds
    s_add_u32 m0, m0, 0x400
    s_add_u32 s10, s10, s68
    buffer_load_dwordx4 v26, s[48:51], s10 offen nt lds
    s_add_u32 m0, m0, 0x400
    s_add_u32 s10, s10, s68
    buffer_load_dwordx4 v26, s[48:51], s10 offen nt lds
    s_add_u32 m0, m0, 0x400
    s_add_u32 s10, s10, s68
    buffer_load_dwordx4 v26, s[48:51], s10 offen nt lds
    s_add_u32 m0, m0, 0x400
    s_add_u32 s10, s10, s68
    buffer_load_dwordx4 v26, s[48:51], s10 offen nt lds
    s_add_u32 m0, m0, 0x400
    s_add_u32 s10, s10, s68
    buffer_load_dwordx4 v26, s[48:51], s10 offen nt lds
    s_add_u32 m0, m0, 0x400
    s_add_u32 s10, s10, s68
    buffer_load_dwordx4 v26, s[48:51], s10 offen nt lds
    s_add_u32 m0, m0, 0x400
    s_add_u32 s10, s10, s68
    buffer_load_dwordx4 v26, s[48:51], s10 offen nt lds
    s_add_u32 m0, m0, 0x400
    s_add_u32 s10, s10, s68
    buffer_load_dwordx4 v26, s[48:51], s10 offen nt lds
    s_add_u32 m0, m0, 0x400
    s_add_u32 s10, s10, s68
    buffer_load_dwordx4 v26, s[48:51], s10 offen nt lds
    s_add_u32 m0, m0, 0x400
    s_add_u32 s10, s10, s68
    buffer_load_dwordx4 v26, s[48:51], s10 offen nt lds
    s_add_u32 m0, m0, 0x400
    s_add_u32 s10, s10, s68
    buffer_load_dwordx4 v26, s[48:51], s10 offen nt lds
    s_add_u32 m0, m0, 0x400
    s_add_u32 s10, s10, s68
    buffer_load_dwordx4 v26, s[48:51], s10 offen nt lds
    s_add_u32 m0, m0, 0x400
    s_add_u32 s10, s10, s68
    buffer_load_dwordx4 v26, s[48:51], s10 offen nt lds
    s_add_u32 m0, m0, 0x400
    s_add_u32 s10, s10, s68
    buffer_load_dwordx4 v26, s[48:51], s10 offen nt lds
    s_barrier
    s_add_u32 s52, s40, 0x1f400000
    s_addc_u32 s53, s41, 0
    s_mov_b32 s54, 0x130000
    s_mov_b32 s55, 0x00020000
    v_lshrrev_b32 v28, 2, v25
    v_lshlrev_b32 v28, 6, v28
    v_lshl_add_u32 v28, v24, 9, v28
    v_lshl_add_u32 v28, v27, 3, v28
    v_add_u32 v28, s73, v28
    v_mul_u32_u24 v29, 1280, v27
    v_lshl_add_u32 v29, v24, 4, v29
    s_mul_i32 s12, s11, 640
    s_add_u32 s12, s12, s75
    v_add_u32 v29, s12, v29
    v_lshlrev_b32 v30, 7, v27
    v_lshl_add_u32 v30, v24, 4, v30
    v_bfe_u32 v31, v0, 2, 1
    v_lshl_add_u32 v30, v31, 6, v30
    s_waitcnt vmcnt(20)
    ds_read_b128 v[96:99], v29 offset:0
    ds_read_b128 v[100:103], v29 offset:64
    ds_read_b128 v[104:107], v29 offset:128
    ds_read_b128 v[108:111], v29 offset:192
    ds_read_b128 v[112:115], v29 offset:256
    ds_read_b128 v[116:119], v29 offset:320
    ds_read_b128 v[120:123], v29 offset:384
    ds_read_b128 v[124:127], v29 offset:448
    ds_read_b128 v[128:131], v29 offset:512
    ds_read_b128 v[132:135], v29 offset:576
    s_waitcnt vmcnt(16)
    ds_read_b64_tr_b16 v[176:177], v28 offset:0
    ds_read_b64_tr_b16 v[178:179], v28 offset:256
    ds_read_b64_tr_b16 v[180:181], v28 offset:32
    ds_read_b64_tr_b16 v[182:183], v28 offset:288
    ds_read_b64_tr_b16 v[184:185], v28 offset:2048
    ds_read_b64_tr_b16 v[186:187], v28 offset:2304
    ds_read_b64_tr_b16 v[188:189], v28 offset:2080
    ds_read_b64_tr_b16 v[190:191], v28 offset:2336
    s_waitcnt vmcnt(12)
    s_lshl_b32 s5, s3, 7
    buffer_load_dword v60, off, s[56:59], s5 sc1
    ds_read_b64_tr_b16 v[192:193], v28 offset:4096
    ds_read_b64_tr_b16 v[194:195], v28 offset:4352
    ds_read_b64_tr_b16 v[196:197], v28 offset:4128
    ds_read_b64_tr_b16 v[198:199], v28 offset:4384
    ds_read_b64_tr_b16 v[200:201], v28 offset:6144
    ds_read_b64_tr_b16 v[202:203], v28 offset:6400
    ds_read_b64_tr_b16 v[204:205], v28 offset:6176
    ds_read_b64_tr_b16 v[206:207], v28 offset:6432
    s_waitcnt lgkmcnt(8)
    v_mfma_f32_16x16x32_bf16 v[32:35], v[176:179], v[96:99], 0
    v_mfma_f32_16x16x32_bf16 v[36:39], v[180:183], v[96:99], 0
    v_mfma_f32_16x16x32_bf16 v[32:35], v[184:187], v[100:103], v[32:35]
    v_mfma_f32_16x16x32_bf16 v[36:39], v[188:191], v[100:103], v[36:39]
    s_waitcnt vmcnt(9)
    ds_read_b64_tr_b16 v[176:177], v28 offset:8192
    ds_read_b64_tr_b16 v[178:179], v28 offset:8448
    ds_read_b64_tr_b16 v[180:181], v28 offset:8224
    ds_read_b64_tr_b16 v[182:183], v28 offset:8480
    ds_read_b64_tr_b16 v[184:185], v28 offset:10240
    ds_read_b64_tr_b16 v[186:187], v28 offset:10496
    ds_read_b64_tr_b16 v[188:189], v28 offset:10272
    ds_read_b64_tr_b16 v[190:191], v28 offset:10528
    s_waitcnt lgkmcnt(8)
    v_mfma_f32_16x16x32_bf16 v[32:35], v[192:195], v[104:107], v[32:35]
    v_mfma_f32_16x16x32_bf16 v[36:39], v[196:199], v[104:107], v[36:39]
    v_mfma_f32_16x16x32_bf16 v[32:35], v[200:203], v[108:111], v[32:35]
    v_mfma_f32_16x16x32_bf16 v[36:39], v[204:207], v[108:111], v[36:39]
    s_waitcnt vmcnt(5)
    ds_read_b64_tr_b16 v[192:193], v28 offset:12288
    ds_read_b64_tr_b16 v[194:195], v28 offset:12544
    ds_read_b64_tr_b16 v[196:197], v28 offset:12320
    ds_read_b64_tr_b16 v[198:199], v28 offset:12576
    ds_read_b64_tr_b16 v[200:201], v28 offset:14336
    ds_read_b64_tr_b16 v[202:203], v28 offset:14592
    ds_read_b64_tr_b16 v[204:205], v28 offset:14368
    ds_read_b64_tr_b16 v[206:207], v28 offset:14624
    s_waitcnt lgkmcnt(8)
    v_mfma_f32_16x16x32_bf16 v[32:35], v[176:179], v[112:115], v[32:35]
    v_mfma_f32_16x16x32_bf16 v[36:39], v[180:183], v[112:115], v[36:39]
    v_mfma_f32_16x16x32_bf16 v[32:35], v[184:187], v[116:119], v[32:35]
    v_mfma_f32_16x16x32_bf16 v[36:39], v[188:191], v[116:119], v[36:39]
    s_waitcnt vmcnt(1)
    ds_read_b64_tr_b16 v[176:177], v28 offset:16384
    ds_read_b64_tr_b16 v[178:179], v28 offset:16640
    ds_read_b64_tr_b16 v[180:181], v28 offset:16416
    ds_read_b64_tr_b16 v[182:183], v28 offset:16672
    ds_read_b64_tr_b16 v[184:185], v28 offset:18432
    ds_read_b64_tr_b16 v[186:187], v28 offset:18688
    ds_read_b64_tr_b16 v[188:189], v28 offset:18464
    ds_read_b64_tr_b16 v[190:191], v28 offset:18720
    s_waitcnt lgkmcnt(8)
    v_mfma_f32_16x16x32_bf16 v[32:35], v[192:195], v[120:123], v[32:35]
    v_mfma_f32_16x16x32_bf16 v[36:39], v[196:199], v[120:123], v[36:39]
    v_mfma_f32_16x16x32_bf16 v[32:35], v[200:203], v[124:127], v[32:35]
    v_mfma_f32_16x16x32_bf16 v[36:39], v[204:207], v[124:127], v[36:39]
    s_waitcnt lgkmcnt(0)
    v_mfma_f32_16x16x32_bf16 v[32:35], v[176:179], v[128:131], v[32:35]
    v_mfma_f32_16x16x32_bf16 v[36:39], v[180:183], v[128:131], v[36:39]
    v_mfma_f32_16x16x32_bf16 v[32:35], v[184:187], v[132:135], v[32:35]
    v_mfma_f32_16x16x32_bf16 v[36:39], v[188:191], v[132:135], v[36:39]
L_nw:
    s_waitcnt vmcnt(0)
    v_readfirstlane_b32 s12, v60
    s_cmp_lg_u32 s12, 0
    s_cbranch_scc1 L_ng
    s_add_u32 s72, s72, 1
    s_cmp_gt_u32 s72, 400000
    s_cbranch_scc1 L_ng
    s_sleep 4
    buffer_load_dword v60, off, s[56:59], 0 sc1
    s_branch L_nw
L_ng:
    ds_write_b32 v95, v60 offset:10920
    s_mov_b32 s64, s12
    s_lshr_b32 s65, s12, 10
    s_lshr_b32 s66, s12, 20
    s_not_b32 s67, s12
    s_lshl_b32 s67, s67, 2
    s_lshr_b32 s12, s12, 30
    s_or_b32 s67, s67, s12
    s_nop 1
    v_mov_b32_dpp v32, v36 quad_perm:[0,1,2,3] row_mask:0xf bank_mask:0x2
    v_mov_b32_dpp v33, v37 quad_perm:[0,1,2,3] row_mask:0xf bank_mask:0x2
    v_mov_b32_dpp v34, v38 quad_perm:[0,1,2,3] row_mask:0xf bank_mask:0x2
    v_mov_b32_dpp v35, v39 quad_perm:[0,1,2,3] row_mask:0xf bank_mask:0x2
    v_add_u32 v32, 0x200, v32
    v_add_u32 v33, 0x200, v33
    v_add_u32 v34, 0x200, v34
    v_add_u32 v35, 0x200, v35
    v_bfi_b32 v32, v93, s64, v32
    v_bfi_b32 v33, v93, s65, v33
    v_bfi_b32 v34, v93, s66, v34
    v_bfi_b32 v35, v93, s67, v35
    s_mov_b32 exec_lo, 0x00ff00ff
    s_mov_b32 exec_hi, 0x00ff00ff
    buffer_store_dwordx4 v[32:35], v30, s[52:55], s70 offen sc1
    s_mov_b64 exec, -1
    s_cmp_lg_u32 s3, 0
    s_cbranch_scc1 L_wo
    s_lshl_b32 s10, s6, 5
    s_add_u32 s10, s10, s7
    s_lshl_b32 s10, s10, 7
    s_add_u32 s10, s10, 0xd0000
    v_lshrrev_b32 v48, 3, v0
    v_lshlrev_b32 v48, 9, v48
    v_and_b32 v3, 7, v0
    v_lshl_add_u32 v48, v3, 4, v48
    v_and_b32 v3, 31, v0
    v_lshlrev_b32 v3, 3, v3
    v_lshrrev_b32 v47, 5, v0
    v_lshl_add_u32 v3, v47, 1, v3
    s_waitcnt vmcnt(0)
L_yp3:
    buffer_load_dwordx4 v[40:43], v48, s[52:55], s10 offen sc1
    s_waitcnt vmcnt(0)
    v_xor_b32 v44, s64, v40
    v_xor_b32 v45, s65, v41
    v_or_b32 v44, v44, v45
    v_xor_b32 v45, s66, v42
    v_xor_b32 v46, s67, v43
    v_or3_b32 v44, v44, v45, v46
    v_and_b32 v44, 0x3ff, v44
    v_cmp_ne_u32 vcc, 0, v44
    s_cbranch_vccz L_yp4
    s_add_u32 s72, s72, 1
    s_cmp_gt_u32 s72, 400000
    s_cbranch_scc1 L_yp4
    s_mov_b64 exec, vcc
    s_sleep 24
    s_branch L_yp3
L_yp4:
    s_mov_b64 exec, -1
    v_and_b32 v40, 0xfffffc00, v40
    v_and_b32 v41, 0xfffffc00, v41
    v_and_b32 v42, 0xfffffc00, v42
    v_and_b32 v43, 0xfffffc00, v43
    s_nop 0
    v_permlane32_swap_b32 v40, v41
    v_permlane32_swap_b32 v42, v43
    s_nop 1
    v_add_f32 v40, v40, v41
    v_add_f32 v42, v42, v43
    v_cvt_pk_bf16_f32 v40, v40, v42
    ds_write_b16 v3, v40 offset:8448
    ds_write_b16_d16_hi v3, v40 offset:8452
    v_mov_b32 v40, 1
    s_waitcnt lgkmcnt(0)
    ds_write_b32 v95, v40 offset:10916
    s_branch L_wo
L_h23:
    s_cmp_lg_u32 s3, 2
    s_cbranch_scc1 L_h3z
    s_cmp_ge_u32 s2, 8
    s_cbranch_scc1 L_hb1
    s_getpc_b64 s[70:71]
L_pc2:
    s_sub_u32 s70, s70, L_pc2-gated_mix__mha_block_cached__glu_gated_bilinear__decode_kernel
    s_subb_u32 s71, s71, 0
    v_lshlrev_b32 v28, 7, v0
    v_min_u32 v27, L_code_end-gated_mix__mha_block_cached__glu_gated_bilinear__decode_kernel-4, v28
    global_load_dword v89, v27, s[70:71]
    v_add_u32 v28, 0x2000, v28
    v_min_u32 v27, L_code_end-gated_mix__mha_block_cached__glu_gated_bilinear__decode_kernel-4, v28
    global_load_dword v89, v27, s[70:71]
    v_add_u32 v28, 0x2000, v28
    v_min_u32 v27, L_code_end-gated_mix__mha_block_cached__glu_gated_bilinear__decode_kernel-4, v28
    global_load_dword v89, v27, s[70:71]
    v_add_u32 v28, 0x2000, v28
    v_min_u32 v27, L_code_end-gated_mix__mha_block_cached__glu_gated_bilinear__decode_kernel-4, v28
    global_load_dword v89, v27, s[70:71]
    v_add_u32 v28, 0x2000, v28
    s_branch L_hb1
L_h3z:
    v_mov_b32 v44, 0
    v_mov_b32 v45, 0
    v_mov_b32 v46, 0
    v_mov_b32 v47, 0
    ds_write_b128 v95, v[44:47] offset:10912
    ds_write_b128 v95, v[44:47] offset:10928
    ds_write_b128 v95, v[44:47] offset:11648
    ds_write_b128 v95, v[44:47] offset:11664
L_hb1:
    s_waitcnt lgkmcnt(0)
    s_barrier
    s_add_u32 s52, s40, 0x1f400000
    s_addc_u32 s53, s41, 0
    s_mov_b32 s54, 0x130000
    s_mov_b32 s55, 0x00020000
    s_mov_b32 s56, s38
    s_mov_b32 s57, s39
    s_mov_b32 s58, 0x100
    s_mov_b32 s59, 0x00020000
    s_cmp_lg_u32 s3, 3
    s_cbranch_scc1 L_wo
L_lw5:
    ds_read_b32 v94, v95 offset:10916
    s_waitcnt lgkmcnt(0)
    v_readfirstlane_b32 s12, v94
    s_cmp_ge_u32 s12, 1
    s_cbranch_scc1 L_lw6
    s_add_u32 s72, s72, 1
    s_cmp_gt_u32 s72, 400000
    s_cbranch_scc1 L_lw6
    s_sleep 4
    s_branch L_lw5
L_lw6:
    s_cmp_ge_u32 s2, 8
    s_cbranch_scc1 L_nwarm
    s_getpc_b64 s[4:5]
L_pc:
    s_sub_u32 s4, s4, L_pc-gated_mix__mha_block_cached__glu_gated_bilinear__decode_kernel
    s_subb_u32 s5, s5, 0
    v_lshlrev_b32 v28, 7, v0
    v_min_u32 v27, L_code_end-gated_mix__mha_block_cached__glu_gated_bilinear__decode_kernel-4, v28
    global_load_dword v89, v27, s[4:5]
    v_add_u32 v28, 0x2000, v28
    v_min_u32 v27, L_code_end-gated_mix__mha_block_cached__glu_gated_bilinear__decode_kernel-4, v28
    global_load_dword v89, v27, s[4:5]
    v_add_u32 v28, 0x2000, v28
    v_min_u32 v27, L_code_end-gated_mix__mha_block_cached__glu_gated_bilinear__decode_kernel-4, v28
    global_load_dword v89, v27, s[4:5]
    v_add_u32 v28, 0x2000, v28
    v_min_u32 v27, L_code_end-gated_mix__mha_block_cached__glu_gated_bilinear__decode_kernel-4, v28
    global_load_dword v89, v27, s[4:5]
    v_add_u32 v28, 0x2000, v28
L_nwarm:
    s_cmp_ge_u32 s2, 80
    s_cbranch_scc1 L_h3c
    s_and_b32 s5, s2, 3
    s_mov_b32 s60, s16
    s_mov_b32 s61, s17
    s_mov_b32 s62, 0x1400
    s_mov_b32 s63, 0x00020000
    s_mov_b32 s48, s34
    s_mov_b32 s49, s35
    s_mov_b32 s50, 0x500
    s_mov_b32 s51, 0x00020000
    v_lshlrev_b32 v3, 2, v0
    s_mul_i32 s12, s5, 1280
    buffer_load_dword v64, v3, s[60:63], s12 offen offset:0
    buffer_load_dword v72, v3, s[48:51], 0 offen offset:0
    buffer_load_dword v65, v3, s[60:63], s12 offen offset:256
    buffer_load_dword v73, v3, s[48:51], 0 offen offset:256
    buffer_load_dword v66, v3, s[60:63], s12 offen offset:512
    buffer_load_dword v74, v3, s[48:51], 0 offen offset:512
    buffer_load_dword v67, v3, s[60:63], s12 offen offset:768
    buffer_load_dword v75, v3, s[48:51], 0 offen offset:768
    buffer_load_dword v68, v3, s[60:63], s12 offen offset:1024
    buffer_load_dword v76, v3, s[48:51], 0 offen offset:1024
    s_waitcnt vmcnt(0)
    v_mov_b32 v91, 0
    v_lshlrev_b32 v80, 16, v64
    v_and_b32 v81, 0xffff0000, v64
    v_lshlrev_b32 v82, 16, v72
    v_and_b32 v83, 0xffff0000, v72
    v_mul_f32 v80, v80, v82
    v_mul_f32 v81, v81, v83
    v_cvt_pk_bf16_f32 v80, v80, v81
    v_lshlrev_b32 v81, 16, v80
    v_and_b32 v80, 0xffff0000, v80
    v_add_f32 v91, v91, v81
    v_add_f32 v91, v91, v80
    v_lshlrev_b32 v80, 16, v65
    v_and_b32 v81, 0xffff0000, v65
    v_lshlrev_b32 v82, 16, v73
    v_and_b32 v83, 0xffff0000, v73
    v_mul_f32 v80, v80, v82
    v_mul_f32 v81, v81, v83
    v_cvt_pk_bf16_f32 v80, v80, v81
    v_lshlrev_b32 v81, 16, v80
    v_and_b32 v80, 0xffff0000, v80
    v_add_f32 v91, v91, v81
    v_add_f32 v91, v91, v80
    v_lshlrev_b32 v80, 16, v66
    v_and_b32 v81, 0xffff0000, v66
    v_lshlrev_b32 v82, 16, v74
    v_and_b32 v83, 0xffff0000, v74
    v_mul_f32 v80, v80, v82
    v_mul_f32 v81, v81, v83
    v_cvt_pk_bf16_f32 v80, v80, v81
    v_lshlrev_b32 v81, 16, v80
    v_and_b32 v80, 0xffff0000, v80
    v_add_f32 v91, v91, v81
    v_add_f32 v91, v91, v80
    v_lshlrev_b32 v80, 16, v67
    v_and_b32 v81, 0xffff0000, v67
    v_lshlrev_b32 v82, 16, v75
    v_and_b32 v83, 0xffff0000, v75
    v_mul_f32 v80, v80, v82
    v_mul_f32 v81, v81, v83
    v_cvt_pk_bf16_f32 v80, v80, v81
    v_lshlrev_b32 v81, 16, v80
    v_and_b32 v80, 0xffff0000, v80
    v_add_f32 v91, v91, v81
    v_add_f32 v91, v91, v80
    v_lshlrev_b32 v80, 16, v68
    v_and_b32 v81, 0xffff0000, v68
    v_lshlrev_b32 v82, 16, v76
    v_and_b32 v83, 0xffff0000, v76
    v_mul_f32 v80, v80, v82
    v_mul_f32 v81, v81, v83
    v_cvt_pk_bf16_f32 v80, v80, v81
    v_lshlrev_b32 v81, 16, v80
    v_and_b32 v80, 0xffff0000, v80
    v_add_f32 v91, v91, v81
    v_add_f32 v91, v91, v80
    s_nop 1
    v_add_f32_dpp v91, v91, v91 row_ror:8 row_mask:0xf bank_mask:0xf
    s_nop 1
    v_add_f32_dpp v91, v91, v91 row_ror:4 row_mask:0xf bank_mask:0xf
    s_nop 1
    v_add_f32_dpp v91, v91, v91 row_ror:2 row_mask:0xf bank_mask:0xf
    s_nop 1
    v_add_f32_dpp v91, v91, v91 row_ror:1 row_mask:0xf bank_mask:0xf
    v_mov_b32 v80, v91
    s_nop 1
    v_permlane16_swap_b32 v91, v80
    s_nop 1
    v_add_f32 v91, v91, v80
    v_mov_b32 v80, v91
    s_nop 1
    v_permlane32_swap_b32 v91, v80
    s_nop 1
    v_add_f32 v91, v91, v80
    v_cvt_pk_bf16_f32 v91, v91, v91
    v_lshlrev_b32 v91, 16, v91
    v_mul_f32 v91, 0xbfb8aa3b, v91
    v_exp_f32 v91, v91
    s_nop 0
    v_add_f32 v91, 1.0, v91
    v_rcp_f32 v91, v91
    s_nop 0
    v_cvt_pk_bf16_f32 v91, v91, v91
    v_lshlrev_b32 v91, 16, v91
L_h3c:
    ds_read_b32 v62, v95 offset:10920
    s_waitcnt lgkmcnt(0)
    v_xor_b32 v63, 0x9e3779b9, v62
    s_and_b32 s10, s2, 127
    s_lshl_b32 s10, s10, 1
    s_add_u32 s10, s10, s8
    s_lshl_b32 s10, s10, 6
    s_add_u32 s10, s10, 0x110000
L_lw7:
    ds_read_b32 v94, v95 offset:10924
    s_waitcnt lgkmcnt(0)
    v_readfirstlane_b32 s12, v94
    s_cmp_ge_u32 s12, 4
    s_cbranch_scc1 L_lw8
    s_add_u32 s72, s72, 1
    s_cmp_gt_u32 s72, 400000
    s_cbranch_scc1 L_lw8
    s_sleep 4
    s_branch L_lw7
L_lw8:
    s_memrealtime s[4:5]
    s_waitcnt lgkmcnt(0)
    v_mov_b32 v60, s4
    v_mov_b32 v61, s4
    s_mov_b64 exec, 1
    buffer_store_dwordx4 v[60:63], off, s[52:55], s10 sc1
    s_mov_b64 exec, -1
    s_waitcnt vmcnt(0)
    v_lshrrev_b32 v48, 1, v0
    v_mul_u32_u24 v49, 5, v48
    s_lshr_b32 s13, s2, 3
    s_add_u32 s13, s13, 3
    v_add_u32 v49, s13, v49
    v_and_b32 v49, 15, v49
    v_lshl_add_u32 v48, v49, 3, v48
    v_lshlrev_b32 v48, 7, v48
    v_and_b32 v49, 1, v0
    v_lshl_add_u32 v48, v49, 6, v48
    s_mov_b32 s10, 0x110000
    s_mov_b64 exec, 0xffff
L_tp9:
    buffer_load_dwordx4 v[40:43], v48, s[52:55], s10 offen sc1
    s_waitcnt vmcnt(0)
    v_xor_b32 v42, v42, v62
    v_xor_b32 v43, v43, v63
    v_or_b32 v42, v42, v43
    v_cmp_ne_u32 vcc, 0, v42
    s_cbranch_vccz L_tp10
    s_add_u32 s72, s72, 1
    s_cmp_gt_u32 s72, 400000
    s_cbranch_scc1 L_tp10
    s_mov_b64 exec, vcc
    s_sleep 32
    s_branch L_tp9
L_tp10:
    s_mov_b64 exec, -1
    v_subrev_u32 v40, s4, v40
    v_cvt_f32_i32 v40, v40
    s_nop 1
    v_add_f32_dpp v40, v40, v40 row_ror:8 row_mask:0xf bank_mask:0xf
    s_nop 1
    v_add_f32_dpp v40, v40, v40 row_ror:4 row_mask:0xf bank_mask:0xf
    s_nop 1
    v_add_f32_dpp v40, v40, v40 row_ror:2 row_mask:0xf bank_mask:0xf
    s_nop 1
    v_add_f32_dpp v40, v40, v40 row_ror:1 row_mask:0xf bank_mask:0xf
    v_mul_f32 v40, 0.0625, v40
    v_cvt_i32_f32 v40, v40
    s_sub_u32 s4, s4, 0
    v_add_u32 v40, s4, v40
    v_or_b32 v40, 1, v40
    s_mov_b64 exec, 1
    ds_write_b32 v95, v40 offset:10932
    s_mov_b64 exec, -1
L_wo:
    s_mul_i32 s13, s6, 163840
    s_mul_i32 s12, s3, 10240
    s_sub_u32 s12, s12, 10240
    s_add_u32 s13, s13, s12
    s_add_u32 s68, s12, 64000
    v_lshrrev_b32 v26, 4, v0
    v_bfe_u32 v27, v0, 2, 1
    v_lshl_add_u32 v26, v26, 2, v27
    v_mul_u32_u24 v26, 1280, v26
    v_bfe_u32 v79, v0, 3, 1
    v_lshl_add_u32 v26, v79, 6, v26
    v_lshlrev_b32 v79, 5, v79
    v_and_b32 v27, 3, v0
    v_lshl_add_u32 v26, v27, 3, v26
    s_mul_i32 s12, s3, 320
    s_add_u32 s12, s12, 64000
    v_add_u32 v84, s12, v26
    v_add_u32 v85, 40960, v84
    v_sub_u32 v78, v84, v79
    v_add_u32 v79, 40960, v78
    s_lshl_b32 s12, s3, 2
    v_mov_b32 v90, s12
    s_mov_b32 s48, s24
    s_mov_b32 s49, s25
    s_mov_b32 s50, 0x500000
    s_mov_b32 s51, 0x00020000
L_lw11:
    ds_read_b32 v94, v95 offset:10916
    s_waitcnt lgkmcnt(0)
    v_readfirstlane_b32 s12, v94
    s_cmp_ge_u32 s12, 1
    s_cbranch_scc1 L_lw12
    s_add_u32 s72, s72, 1
    s_cmp_gt_u32 s72, 400000
    s_cbranch_scc1 L_lw12
    s_sleep 4
    s_branch L_lw11
L_lw12:
    s_sub_u32 s12, s3, 1
    s_cmp_lt_u32 s12, 2
    s_cbranch_scc1 L_ld
L_fw13:
    ds_read_b64 v[80:81], v95 offset:11664
    s_waitcnt lgkmcnt(0)
    v_min_u32 v80, v80, v81
    s_nop 0
    v_readfirstlane_b32 s12, v80
    s_cmp_ge_u32 s12, 1
    s_cbranch_scc1 L_fw14
    s_add_u32 s72, s72, 1
    s_cmp_gt_u32 s72, 400000
    s_cbranch_scc1 L_fw14
    s_sleep 8
    s_branch L_fw13
L_fw14:
    ds_read_b64_tr_b16 v[96:97], v84 offset:0
    ds_read_b64_tr_b16 v[98:99], v84 offset:2560
    ds_read_b64_tr_b16 v[128:129], v84 offset:32
    ds_read_b64_tr_b16 v[130:131], v84 offset:2592
    ds_read_b64_tr_b16 v[160:161], v84 offset:128
    ds_read_b64_tr_b16 v[162:163], v84 offset:2688
    ds_read_b64_tr_b16 v[192:193], v84 offset:160
    ds_read_b64_tr_b16 v[194:195], v84 offset:2720
    ds_read_b64_tr_b16 v[224:225], v78 offset:256
    ds_read_b64_tr_b16 v[226:227], v78 offset:2816
    s_waitcnt lgkmcnt(0)
    v_mov_b32 v80, 1
    ds_write_b32 v90, v80 offset:11648
L_fw15:
    ds_read_b64 v[80:81], v95 offset:11664
    s_waitcnt lgkmcnt(0)
    v_min_u32 v80, v80, v81
    s_nop 0
    v_readfirstlane_b32 s12, v80
    s_cmp_ge_u32 s12, 2
    s_cbranch_scc1 L_fw16
    s_add_u32 s72, s72, 1
    s_cmp_gt_u32 s72, 400000
    s_cbranch_scc1 L_fw16
    s_sleep 8
    s_branch L_fw15
L_fw16:
    ds_read_b64_tr_b16 v[100:101], v84 offset:20480
    ds_read_b64_tr_b16 v[102:103], v84 offset:23040
    ds_read_b64_tr_b16 v[132:133], v84 offset:20512
    ds_read_b64_tr_b16 v[134:135], v84 offset:23072
    ds_read_b64_tr_b16 v[164:165], v84 offset:20608
    ds_read_b64_tr_b16 v[166:167], v84 offset:23168
    ds_read_b64_tr_b16 v[196:197], v84 offset:20640
    ds_read_b64_tr_b16 v[198:199], v84 offset:23200
    ds_read_b64_tr_b16 v[228:229], v78 offset:20736
    ds_read_b64_tr_b16 v[230:231], v78 offset:23296
    s_waitcnt lgkmcnt(0)
    v_mov_b32 v80, 2
    ds_write_b32 v90, v80 offset:11648
L_fw17:
    ds_read_b64 v[80:81], v95 offset:11664
    s_waitcnt lgkmcnt(0)
    v_min_u32 v80, v80, v81
    s_nop 0
    v_readfirstlane_b32 s12, v80
    s_cmp_ge_u32 s12, 3
    s_cbranch_scc1 L_fw18
    s_add_u32 s72, s72, 1
    s_cmp_gt_u32 s72, 400000
    s_cbranch_scc1 L_fw18
    s_sleep 8
    s_branch L_fw17
L_fw18:
    ds_read_b64_tr_b16 v[104:105], v85 offset:0
    ds_read_b64_tr_b16 v[106:107], v85 offset:2560
    ds_read_b64_tr_b16 v[136:137], v85 offset:32
    ds_read_b64_tr_b16 v[138:139], v85 offset:2592
    ds_read_b64_tr_b16 v[168:169], v85 offset:128
    ds_read_b64_tr_b16 v[170:171], v85 offset:2688
    ds_read_b64_tr_b16 v[200:201], v85 offset:160
    ds_read_b64_tr_b16 v[202:203], v85 offset:2720
    ds_read_b64_tr_b16 v[232:233], v79 offset:256
    ds_read_b64_tr_b16 v[234:235], v79 offset:2816
    s_waitcnt lgkmcnt(0)
    v_mov_b32 v80, 3
    ds_write_b32 v90, v80 offset:11648
L_fw19:
    ds_read_b64 v[80:81], v95 offset:11664
    s_waitcnt lgkmcnt(0)
    v_min_u32 v80, v80, v81
    s_nop 0
    v_readfirstlane_b32 s12, v80
    s_cmp_ge_u32 s12, 4
    s_cbranch_scc1 L_fw20
    s_add_u32 s72, s72, 1
    s_cmp_gt_u32 s72, 400000
    s_cbranch_scc1 L_fw20
    s_sleep 8
    s_branch L_fw19
L_fw20:
    ds_read_b64_tr_b16 v[108:109], v85 offset:20480
    ds_read_b64_tr_b16 v[110:111], v85 offset:23040
    ds_read_b64_tr_b16 v[140:141], v85 offset:20512
    ds_read_b64_tr_b16 v[142:143], v85 offset:23072
    ds_read_b64_tr_b16 v[172:173], v85 offset:20608
    ds_read_b64_tr_b16 v[174:175], v85 offset:23168
    ds_read_b64_tr_b16 v[204:205], v85 offset:20640
    ds_read_b64_tr_b16 v[206:207], v85 offset:23200
    ds_read_b64_tr_b16 v[236:237], v79 offset:20736
    ds_read_b64_tr_b16 v[238:239], v79 offset:23296
    s_waitcnt lgkmcnt(0)
    v_mov_b32 v80, 4
    ds_write_b32 v90, v80 offset:11648
    s_branch L_prep
L_ld:
    s_add_u32 m0, s68, 0
    s_nop 0
    buffer_load_dwordx4 v2, s[48:51], s13 offen nt lds
    s_add_u32 s13, s13, 1024
    s_add_u32 m0, s68, 1024
    s_nop 0
    buffer_load_dwordx4 v2, s[48:51], s13 offen nt lds
    s_add_u32 s13, s13, 1024
    s_add_u32 m0, s68, 2048
    s_nop 0
    buffer_load_dwordx4 v2, s[48:51], s13 offen nt lds
    s_add_u32 s13, s13, 1024
    s_add_u32 m0, s68, 3072
    s_nop 0
    buffer_load_dwordx4 v2, s[48:51], s13 offen nt lds
    s_add_u32 s13, s13, 1024
    s_add_u32 m0, s68, 4096
    s_nop 0
    buffer_load_dwordx4 v2, s[48:51], s13 offen nt lds
    s_add_u32 s13, s13, 1024
    s_add_u32 m0, s68, 5120
    s_waitcnt vmcnt(4)
    buffer_load_dwordx4 v2, s[48:51], s13 offen nt lds
    s_add_u32 s13, s13, 1024
    s_add_u32 m0, s68, 6144
    s_waitcnt vmcnt(4)
    buffer_load_dwordx4 v2, s[48:51], s13 offen nt lds
    s_add_u32 s13, s13, 1024
    s_add_u32 m0, s68, 7168
    s_waitcnt vmcnt(4)
    buffer_load_dwordx4 v2, s[48:51], s13 offen nt lds
    s_add_u32 s13, s13, 1024
    s_add_u32 m0, s68, 8192
    s_waitcnt vmcnt(4)
    buffer_load_dwordx4 v2, s[48:51], s13 offen nt lds
    s_add_u32 s13, s13, 1024
    s_add_u32 m0, s68, 9216
    s_waitcnt vmcnt(4)
    buffer_load_dwordx4 v2, s[48:51], s13 offen nt lds
    s_add_u32 s13, s13, 11264
    s_add_u32 m0, s68, 20480
    s_waitcnt vmcnt(4)
    buffer_load_dwordx4 v2, s[48:51], s13 offen nt lds
    s_add_u32 s13, s13, 1024
    s_add_u32 m0, s68, 21504
    s_waitcnt vmcnt(4)
    buffer_load_dwordx4 v2, s[48:51], s13 offen nt lds
    s_add_u32 s13, s13, 1024
    s_add_u32 m0, s68, 22528
    s_waitcnt vmcnt(4)
    buffer_load_dwordx4 v2, s[48:51], s13 offen nt lds
    s_add_u32 s13, s13, 1024
    s_add_u32 m0, s68, 23552
    s_waitcnt vmcnt(4)
    buffer_load_dwordx4 v2, s[48:51], s13 offen nt lds
    s_add_u32 s13, s13, 1024
    s_add_u32 m0, s68, 24576
    s_waitcnt vmcnt(4)
    v_mov_b32 v80, 1
    ds_write_b32 v90, v80 offset:11660
    buffer_load_dwordx4 v2, s[48:51], s13 offen nt lds
    s_add_u32 s13, s13, 1024
    s_add_u32 m0, s68, 25600
    s_waitcnt vmcnt(4)
    buffer_load_dwordx4 v2, s[48:51], s13 offen nt lds
    s_add_u32 s13, s13, 1024
    s_add_u32 m0, s68, 26624
    s_waitcnt vmcnt(4)
    buffer_load_dwordx4 v2, s[48:51], s13 offen nt lds
    s_add_u32 s13, s13, 1024
    s_add_u32 m0, s68, 27648
    s_waitcnt vmcnt(4)
    buffer_load_dwordx4 v2, s[48:51], s13 offen nt lds
    s_add_u32 s13, s13, 1024
    s_add_u32 m0, s68, 28672
    s_waitcnt vmcnt(4)
    buffer_load_dwordx4 v2, s[48:51], s13 offen nt lds
    s_add_u32 s13, s13, 1024
    s_add_u32 m0, s68, 29696
    s_waitcnt vmcnt(4)
    buffer_load_dwordx4 v2, s[48:51], s13 offen nt lds
    s_add_u32 s13, s13, 11264
L_fw21:
    ds_read_b64 v[80:81], v95 offset:11664
    s_waitcnt lgkmcnt(0)
    v_min_u32 v80, v80, v81
    s_nop 0
    v_readfirstlane_b32 s12, v80
    s_cmp_ge_u32 s12, 1
    s_cbranch_scc1 L_fw22
    s_add_u32 s72, s72, 1
    s_cmp_gt_u32 s72, 400000
    s_cbranch_scc1 L_fw22
    s_sleep 8
    s_branch L_fw21
L_fw22:
    ds_read_b64_tr_b16 v[96:97], v84 offset:0
    ds_read_b64_tr_b16 v[98:99], v84 offset:2560
    ds_read_b64_tr_b16 v[128:129], v84 offset:32
    ds_read_b64_tr_b16 v[130:131], v84 offset:2592
    ds_read_b64_tr_b16 v[160:161], v84 offset:128
    ds_read_b64_tr_b16 v[162:163], v84 offset:2688
    ds_read_b64_tr_b16 v[192:193], v84 offset:160
    ds_read_b64_tr_b16 v[194:195], v84 offset:2720
    ds_read_b64_tr_b16 v[224:225], v78 offset:256
    ds_read_b64_tr_b16 v[226:227], v78 offset:2816
    s_waitcnt lgkmcnt(0)
    v_mov_b32 v80, 1
    ds_write_b32 v90, v80 offset:11648
    s_add_u32 m0, s68, 40960
    s_waitcnt vmcnt(4)
    buffer_load_dwordx4 v2, s[48:51], s13 offen nt lds
    s_add_u32 s13, s13, 1024
    s_add_u32 m0, s68, 41984
    s_waitcnt vmcnt(4)
    buffer_load_dwordx4 v2, s[48:51], s13 offen nt lds
    s_add_u32 s13, s13, 1024
    s_add_u32 m0, s68, 43008
    s_waitcnt vmcnt(4)
    buffer_load_dwordx4 v2, s[48:51], s13 offen nt lds
    s_add_u32 s13, s13, 1024
    s_add_u32 m0, s68, 44032
    s_waitcnt vmcnt(4)
    buffer_load_dwordx4 v2, s[48:51], s13 offen nt lds
    s_add_u32 s13, s13, 1024
    s_add_u32 m0, s68, 45056
    s_waitcnt vmcnt(4)
    v_mov_b32 v80, 2
    ds_write_b32 v90, v80 offset:11660
    buffer_load_dwordx4 v2, s[48:51], s13 offen nt lds
    s_add_u32 s13, s13, 1024
    s_add_u32 m0, s68, 46080
    s_waitcnt vmcnt(4)
    buffer_load_dwordx4 v2, s[48:51], s13 offen nt lds
    s_add_u32 s13, s13, 1024
    s_add_u32 m0, s68, 47104
    s_waitcnt vmcnt(4)
    buffer_load_dwordx4 v2, s[48:51], s13 offen nt lds
    s_add_u32 s13, s13, 1024
    s_add_u32 m0, s68, 48128
    s_waitcnt vmcnt(4)
    buffer_load_dwordx4 v2, s[48:51], s13 offen nt lds
    s_add_u32 s13, s13, 1024
    s_add_u32 m0, s68, 49152
    s_waitcnt vmcnt(4)
    buffer_load_dwordx4 v2, s[48:51], s13 offen nt lds
    s_add_u32 s13, s13, 1024
    s_add_u32 m0, s68, 50176
    s_waitcnt vmcnt(4)
    buffer_load_dwordx4 v2, s[48:51], s13 offen nt lds
    s_add_u32 s13, s13, 11264
L_fw23:
    ds_read_b64 v[80:81], v95 offset:11664
    s_waitcnt lgkmcnt(0)
    v_min_u32 v80, v80, v81
    s_nop 0
    v_readfirstlane_b32 s12, v80
    s_cmp_ge_u32 s12, 2
    s_cbranch_scc1 L_fw24
    s_add_u32 s72, s72, 1
    s_cmp_gt_u32 s72, 400000
    s_cbranch_scc1 L_fw24
    s_sleep 8
    s_branch L_fw23
L_fw24:
    ds_read_b64_tr_b16 v[100:101], v84 offset:20480
    ds_read_b64_tr_b16 v[102:103], v84 offset:23040
    ds_read_b64_tr_b16 v[132:133], v84 offset:20512
    ds_read_b64_tr_b16 v[134:135], v84 offset:23072
    ds_read_b64_tr_b16 v[164:165], v84 offset:20608
    ds_read_b64_tr_b16 v[166:167], v84 offset:23168
    ds_read_b64_tr_b16 v[196:197], v84 offset:20640
    ds_read_b64_tr_b16 v[198:199], v84 offset:23200
    ds_read_b64_tr_b16 v[228:229], v78 offset:20736
    ds_read_b64_tr_b16 v[230:231], v78 offset:23296
    s_waitcnt lgkmcnt(0)
    v_mov_b32 v80, 2
    ds_write_b32 v90, v80 offset:11648
    s_add_u32 m0, s68, 61440
    s_waitcnt vmcnt(4)
    buffer_load_dwordx4 v2, s[48:51], s13 offen nt lds
    s_add_u32 s13, s13, 1024
    s_add_u32 m0, s68, 62464
    s_waitcnt vmcnt(4)
    buffer_load_dwordx4 v2, s[48:51], s13 offen nt lds
    s_add_u32 s13, s13, 1024
    s_add_u32 m0, s68, 63488
    s_waitcnt vmcnt(4)
    buffer_load_dwordx4 v2, s[48:51], s13 offen nt lds
    s_add_u32 s13, s13, 1024
    s_add_u32 m0, s68, 64512
    s_waitcnt vmcnt(4)
    buffer_load_dwordx4 v2, s[48:51], s13 offen nt lds
    s_add_u32 s13, s13, 1024
    s_add_u32 m0, s68, 65536
    s_waitcnt vmcnt(4)
    v_mov_b32 v80, 3
    ds_write_b32 v90, v80 offset:11660
    buffer_load_dwordx4 v2, s[48:51], s13 offen nt lds
    s_add_u32 s13, s13, 1024
    s_add_u32 m0, s68, 66560
    s_waitcnt vmcnt(4)
    buffer_load_dwordx4 v2, s[48:51], s13 offen nt lds
    s_add_u32 s13, s13, 1024
    s_add_u32 m0, s68, 67584
    s_waitcnt vmcnt(4)
    buffer_load_dwordx4 v2, s[48:51], s13 offen nt lds
    s_add_u32 s13, s13, 1024
    s_add_u32 m0, s68, 68608
    s_waitcnt vmcnt(4)
    buffer_load_dwordx4 v2, s[48:51], s13 offen nt lds
    s_add_u32 s13, s13, 1024
    s_add_u32 m0, s68, 69632
    s_waitcnt vmcnt(4)
    buffer_load_dwordx4 v2, s[48:51], s13 offen nt lds
    s_add_u32 s13, s13, 1024
    s_add_u32 m0, s68, 70656
    s_waitcnt vmcnt(4)
    buffer_load_dwordx4 v2, s[48:51], s13 offen nt lds
    s_add_u32 s13, s13, 11264
L_fw25:
    ds_read_b64 v[80:81], v95 offset:11664
    s_waitcnt lgkmcnt(0)
    v_min_u32 v80, v80, v81
    s_nop 0
    v_readfirstlane_b32 s12, v80
    s_cmp_ge_u32 s12, 3
    s_cbranch_scc1 L_fw26
    s_add_u32 s72, s72, 1
    s_cmp_gt_u32 s72, 400000
    s_cbranch_scc1 L_fw26
    s_sleep 8
    s_branch L_fw25
L_fw26:
    ds_read_b64_tr_b16 v[104:105], v85 offset:0
    ds_read_b64_tr_b16 v[106:107], v85 offset:2560
    ds_read_b64_tr_b16 v[136:137], v85 offset:32
    ds_read_b64_tr_b16 v[138:139], v85 offset:2592
    ds_read_b64_tr_b16 v[168:169], v85 offset:128
    ds_read_b64_tr_b16 v[170:171], v85 offset:2688
    ds_read_b64_tr_b16 v[200:201], v85 offset:160
    ds_read_b64_tr_b16 v[202:203], v85 offset:2720
    ds_read_b64_tr_b16 v[232:233], v79 offset:256
    ds_read_b64_tr_b16 v[234:235], v79 offset:2816
    s_waitcnt lgkmcnt(0)
    v_mov_b32 v80, 3
    ds_write_b32 v90, v80 offset:11648
L_fw27:
    ds_read_b128 v[80:83], v95 offset:11648
    s_waitcnt lgkmcnt(0)
    v_min_u32 v80, v80, v81
    v_min3_u32 v80, v80, v82, v83
    s_nop 0
    v_readfirstlane_b32 s12, v80
    s_cmp_ge_u32 s12, 1
    s_cbranch_scc1 L_fw28
    s_add_u32 s72, s72, 1
    s_cmp_gt_u32 s72, 400000
    s_cbranch_scc1 L_fw28
    s_sleep 8
    s_branch L_fw27
L_fw28:
    s_add_u32 m0, s68, 0
    s_waitcnt vmcnt(4)
    buffer_load_dwordx4 v2, s[48:51], s13 offen nt lds
    s_add_u32 s13, s13, 1024
    s_add_u32 m0, s68, 1024
    s_waitcnt vmcnt(4)
    buffer_load_dwordx4 v2, s[48:51], s13 offen nt lds
    s_add_u32 s13, s13, 1024
    s_add_u32 m0, s68, 2048
    s_waitcnt vmcnt(4)
    buffer_load_dwordx4 v2, s[48:51], s13 offen nt lds
    s_add_u32 s13, s13, 1024
    s_add_u32 m0, s68, 3072
    s_waitcnt vmcnt(4)
    buffer_load_dwordx4 v2, s[48:51], s13 offen nt lds
    s_add_u32 s13, s13, 1024
    s_add_u32 m0, s68, 4096
    s_waitcnt vmcnt(4)
    v_mov_b32 v80, 4
    ds_write_b32 v90, v80 offset:11660
    buffer_load_dwordx4 v2, s[48:51], s13 offen nt lds
    s_add_u32 s13, s13, 1024
    s_add_u32 m0, s68, 5120
    s_waitcnt vmcnt(4)
    buffer_load_dwordx4 v2, s[48:51], s13 offen nt lds
    s_add_u32 s13, s13, 1024
    s_add_u32 m0, s68, 6144
    s_waitcnt vmcnt(4)
    buffer_load_dwordx4 v2, s[48:51], s13 offen nt lds
    s_add_u32 s13, s13, 1024
    s_add_u32 m0, s68, 7168
    s_waitcnt vmcnt(4)
    buffer_load_dwordx4 v2, s[48:51], s13 offen nt lds
    s_add_u32 s13, s13, 1024
    s_add_u32 m0, s68, 8192
    s_waitcnt vmcnt(4)
    buffer_load_dwordx4 v2, s[48:51], s13 offen nt lds
    s_add_u32 s13, s13, 1024
    s_add_u32 m0, s68, 9216
    s_waitcnt vmcnt(4)
    buffer_load_dwordx4 v2, s[48:51], s13 offen nt lds
    s_add_u32 s13, s13, 11264
L_fw29:
    ds_read_b64 v[80:81], v95 offset:11664
    s_waitcnt lgkmcnt(0)
    v_min_u32 v80, v80, v81
    s_nop 0
    v_readfirstlane_b32 s12, v80
    s_cmp_ge_u32 s12, 4
    s_cbranch_scc1 L_fw30
    s_add_u32 s72, s72, 1
    s_cmp_gt_u32 s72, 400000
    s_cbranch_scc1 L_fw30
    s_sleep 8
    s_branch L_fw29
L_fw30:
    ds_read_b64_tr_b16 v[108:109], v85 offset:20480
    ds_read_b64_tr_b16 v[110:111], v85 offset:23040
    ds_read_b64_tr_b16 v[140:141], v85 offset:20512
    ds_read_b64_tr_b16 v[142:143], v85 offset:23072
    ds_read_b64_tr_b16 v[172:173], v85 offset:20608
    ds_read_b64_tr_b16 v[174:175], v85 offset:23168
    ds_read_b64_tr_b16 v[204:205], v85 offset:20640
    ds_read_b64_tr_b16 v[206:207], v85 offset:23200
    ds_read_b64_tr_b16 v[236:237], v79 offset:20736
    ds_read_b64_tr_b16 v[238:239], v79 offset:23296
    s_waitcnt lgkmcnt(0)
    v_mov_b32 v80, 4
    ds_write_b32 v90, v80 offset:11648
L_fw31:
    ds_read_b128 v[80:83], v95 offset:11648
    s_waitcnt lgkmcnt(0)
    v_min_u32 v80, v80, v81
    v_min3_u32 v80, v80, v82, v83
    s_nop 0
    v_readfirstlane_b32 s12, v80
    s_cmp_ge_u32 s12, 2
    s_cbranch_scc1 L_fw32
    s_add_u32 s72, s72, 1
    s_cmp_gt_u32 s72, 400000
    s_cbranch_scc1 L_fw32
    s_sleep 8
    s_branch L_fw31
L_fw32:
    s_add_u32 m0, s68, 20480
    s_waitcnt vmcnt(4)
    buffer_load_dwordx4 v2, s[48:51], s13 offen nt lds
    s_add_u32 s13, s13, 1024
    s_add_u32 m0, s68, 21504
    s_waitcnt vmcnt(4)
    buffer_load_dwordx4 v2, s[48:51], s13 offen nt lds
    s_add_u32 s13, s13, 1024
    s_add_u32 m0, s68, 22528
    s_waitcnt vmcnt(4)
    buffer_load_dwordx4 v2, s[48:51], s13 offen nt lds
    s_add_u32 s13, s13, 1024
    s_add_u32 m0, s68, 23552
    s_waitcnt vmcnt(4)
    buffer_load_dwordx4 v2, s[48:51], s13 offen nt lds
    s_add_u32 s13, s13, 1024
    s_add_u32 m0, s68, 24576
    s_waitcnt vmcnt(4)
    v_mov_b32 v80, 5
    ds_write_b32 v90, v80 offset:11660
    buffer_load_dwordx4 v2, s[48:51], s13 offen nt lds
    s_add_u32 s13, s13, 1024
    s_add_u32 m0, s68, 25600
    s_waitcnt vmcnt(4)
    buffer_load_dwordx4 v2, s[48:51], s13 offen nt lds
    s_add_u32 s13, s13, 1024
    s_add_u32 m0, s68, 26624
    s_waitcnt vmcnt(4)
    buffer_load_dwordx4 v2, s[48:51], s13 offen nt lds
    s_add_u32 s13, s13, 1024
    s_add_u32 m0, s68, 27648
    s_waitcnt vmcnt(4)
    buffer_load_dwordx4 v2, s[48:51], s13 offen nt lds
    s_add_u32 s13, s13, 1024
    s_add_u32 m0, s68, 28672
    s_waitcnt vmcnt(4)
    buffer_load_dwordx4 v2, s[48:51], s13 offen nt lds
    s_add_u32 s13, s13, 1024
    s_add_u32 m0, s68, 29696
    s_waitcnt vmcnt(4)
    buffer_load_dwordx4 v2, s[48:51], s13 offen nt lds
    s_add_u32 s13, s13, 11264
L_fw33:
    ds_read_b64 v[80:81], v95 offset:11664
    s_waitcnt lgkmcnt(0)
    v_min_u32 v80, v80, v81
    s_nop 0
    v_readfirstlane_b32 s12, v80
    s_cmp_ge_u32 s12, 5
    s_cbranch_scc1 L_fw34
    s_add_u32 s72, s72, 1
    s_cmp_gt_u32 s72, 400000
    s_cbranch_scc1 L_fw34
    s_sleep 8
    s_branch L_fw33
L_fw34:
    ds_read_b64_tr_b16 v[112:113], v84 offset:0
    ds_read_b64_tr_b16 v[114:115], v84 offset:2560
    ds_read_b64_tr_b16 v[144:145], v84 offset:32
    ds_read_b64_tr_b16 v[146:147], v84 offset:2592
    ds_read_b64_tr_b16 v[176:177], v84 offset:128
    ds_read_b64_tr_b16 v[178:179], v84 offset:2688
    ds_read_b64_tr_b16 v[208:209], v84 offset:160
    ds_read_b64_tr_b16 v[210:211], v84 offset:2720
    ds_read_b64_tr_b16 v[240:241], v78 offset:256
    ds_read_b64_tr_b16 v[242:243], v78 offset:2816
    s_waitcnt lgkmcnt(0)
L_fw35:
    ds_read_b128 v[80:83], v95 offset:11648
    s_waitcnt lgkmcnt(0)
    v_min_u32 v80, v80, v81
    v_min3_u32 v80, v80, v82, v83
    s_nop 0
    v_readfirstlane_b32 s12, v80
    s_cmp_ge_u32 s12, 3
    s_cbranch_scc1 L_fw36
    s_add_u32 s72, s72, 1
    s_cmp_gt_u32 s72, 400000
    s_cbranch_scc1 L_fw36
    s_sleep 8
    s_branch L_fw35
L_fw36:
    s_add_u32 m0, s68, 40960
    s_waitcnt vmcnt(4)
    buffer_load_dwordx4 v2, s[48:51], s13 offen nt lds
    s_add_u32 s13, s13, 1024
    s_add_u32 m0, s68, 41984
    s_waitcnt vmcnt(4)
    buffer_load_dwordx4 v2, s[48:51], s13 offen nt lds
    s_add_u32 s13, s13, 1024
    s_add_u32 m0, s68, 43008
    s_waitcnt vmcnt(4)
    buffer_load_dwordx4 v2, s[48:51], s13 offen nt lds
    s_add_u32 s13, s13, 1024
    s_add_u32 m0, s68, 44032
    s_waitcnt vmcnt(4)
    buffer_load_dwordx4 v2, s[48:51], s13 offen nt lds
    s_add_u32 s13, s13, 1024
    s_add_u32 m0, s68, 45056
    s_waitcnt vmcnt(4)
    v_mov_b32 v80, 6
    ds_write_b32 v90, v80 offset:11660
    buffer_load_dwordx4 v2, s[48:51], s13 offen nt lds
    s_add_u32 s13, s13, 1024
    s_add_u32 m0, s68, 46080
    s_waitcnt vmcnt(4)
    buffer_load_dwordx4 v2, s[48:51], s13 offen nt lds
    s_add_u32 s13, s13, 1024
    s_add_u32 m0, s68, 47104
    s_waitcnt vmcnt(4)
    buffer_load_dwordx4 v2, s[48:51], s13 offen nt lds
    s_add_u32 s13, s13, 1024
    s_add_u32 m0, s68, 48128
    s_waitcnt vmcnt(4)
    buffer_load_dwordx4 v2, s[48:51], s13 offen nt lds
    s_add_u32 s13, s13, 1024
    s_add_u32 m0, s68, 49152
    s_waitcnt vmcnt(4)
    buffer_load_dwordx4 v2, s[48:51], s13 offen nt lds
    s_add_u32 s13, s13, 1024
    s_add_u32 m0, s68, 50176
    s_waitcnt vmcnt(4)
    buffer_load_dwordx4 v2, s[48:51], s13 offen nt lds
    s_add_u32 s13, s13, 11264
L_fw37:
    ds_read_b64 v[80:81], v95 offset:11664
    s_waitcnt lgkmcnt(0)
    v_min_u32 v80, v80, v81
    s_nop 0
    v_readfirstlane_b32 s12, v80
    s_cmp_ge_u32 s12, 6
    s_cbranch_scc1 L_fw38
    s_add_u32 s72, s72, 1
    s_cmp_gt_u32 s72, 400000
    s_cbranch_scc1 L_fw38
    s_sleep 8
    s_branch L_fw37
L_fw38:
    ds_read_b64_tr_b16 v[116:117], v84 offset:20480
    ds_read_b64_tr_b16 v[118:119], v84 offset:23040
    ds_read_b64_tr_b16 v[148:149], v84 offset:20512
    ds_read_b64_tr_b16 v[150:151], v84 offset:23072
    ds_read_b64_tr_b16 v[180:181], v84 offset:20608
    ds_read_b64_tr_b16 v[182:183], v84 offset:23168
    ds_read_b64_tr_b16 v[212:213], v84 offset:20640
    ds_read_b64_tr_b16 v[214:215], v84 offset:23200
    ds_read_b64_tr_b16 v[244:245], v78 offset:20736
    ds_read_b64_tr_b16 v[246:247], v78 offset:23296
    s_waitcnt lgkmcnt(0)
L_fw39:
    ds_read_b128 v[80:83], v95 offset:11648
    s_waitcnt lgkmcnt(0)
    v_min_u32 v80, v80, v81
    v_min3_u32 v80, v80, v82, v83
    s_nop 0
    v_readfirstlane_b32 s12, v80
    s_cmp_ge_u32 s12, 4
    s_cbranch_scc1 L_fw40
    s_add_u32 s72, s72, 1
    s_cmp_gt_u32 s72, 400000
    s_cbranch_scc1 L_fw40
    s_sleep 8
    s_branch L_fw39
L_fw40:
    s_add_u32 m0, s68, 61440
    s_waitcnt vmcnt(4)
    buffer_load_dwordx4 v2, s[48:51], s13 offen nt lds
    s_add_u32 s13, s13, 1024
    s_add_u32 m0, s68, 62464
    s_waitcnt vmcnt(4)
    buffer_load_dwordx4 v2, s[48:51], s13 offen nt lds
    s_add_u32 s13, s13, 1024
    s_add_u32 m0, s68, 63488
    s_waitcnt vmcnt(4)
    buffer_load_dwordx4 v2, s[48:51], s13 offen nt lds
    s_add_u32 s13, s13, 1024
    s_add_u32 m0, s68, 64512
    s_waitcnt vmcnt(4)
    buffer_load_dwordx4 v2, s[48:51], s13 offen nt lds
    s_add_u32 s13, s13, 1024
    s_add_u32 m0, s68, 65536
    s_waitcnt vmcnt(4)
    v_mov_b32 v80, 7
    ds_write_b32 v90, v80 offset:11660
    buffer_load_dwordx4 v2, s[48:51], s13 offen nt lds
    s_add_u32 s13, s13, 1024
    s_add_u32 m0, s68, 66560
    s_waitcnt vmcnt(4)
    buffer_load_dwordx4 v2, s[48:51], s13 offen nt lds
    s_add_u32 s13, s13, 1024
    s_add_u32 m0, s68, 67584
    s_waitcnt vmcnt(4)
    buffer_load_dwordx4 v2, s[48:51], s13 offen nt lds
    s_add_u32 s13, s13, 1024
    s_add_u32 m0, s68, 68608
    s_waitcnt vmcnt(4)
    buffer_load_dwordx4 v2, s[48:51], s13 offen nt lds
    s_add_u32 s13, s13, 1024
    s_add_u32 m0, s68, 69632
    s_waitcnt vmcnt(4)
    buffer_load_dwordx4 v2, s[48:51], s13 offen nt lds
    s_add_u32 s13, s13, 1024
    s_add_u32 m0, s68, 70656
    s_waitcnt vmcnt(4)
    buffer_load_dwordx4 v2, s[48:51], s13 offen nt lds
    s_waitcnt vmcnt(0)
    v_mov_b32 v80, 8
    ds_write_b32 v90, v80 offset:11660
L_fw41:
    ds_read_b64 v[80:81], v95 offset:11664
    s_waitcnt lgkmcnt(0)
    v_min_u32 v80, v80, v81
    s_nop 0
    v_readfirstlane_b32 s12, v80
    s_cmp_ge_u32 s12, 7
    s_cbranch_scc1 L_fw42
    s_add_u32 s72, s72, 1
    s_cmp_gt_u32 s72, 400000
    s_cbranch_scc1 L_fw42
    s_sleep 8
    s_branch L_fw41
L_fw42:
    ds_read_b64_tr_b16 v[120:121], v85 offset:0
    ds_read_b64_tr_b16 v[122:123], v85 offset:2560
    ds_read_b64_tr_b16 v[152:153], v85 offset:32
    ds_read_b64_tr_b16 v[154:155], v85 offset:2592
    ds_read_b64_tr_b16 v[184:185], v85 offset:128
    ds_read_b64_tr_b16 v[186:187], v85 offset:2688
    ds_read_b64_tr_b16 v[216:217], v85 offset:160
    ds_read_b64_tr_b16 v[218:219], v85 offset:2720
    ds_read_b64_tr_b16 v[248:249], v79 offset:256
    ds_read_b64_tr_b16 v[250:251], v79 offset:2816
    s_waitcnt lgkmcnt(0)
L_fw43:
    ds_read_b64 v[80:81], v95 offset:11664
    s_waitcnt lgkmcnt(0)
    v_min_u32 v80, v80, v81
    s_nop 0
    v_readfirstlane_b32 s12, v80
    s_cmp_ge_u32 s12, 8
    s_cbranch_scc1 L_fw44
    s_add_u32 s72, s72, 1
    s_cmp_gt_u32 s72, 400000
    s_cbranch_scc1 L_fw44
    s_sleep 8
    s_branch L_fw43
L_fw44:
    ds_read_b64_tr_b16 v[124:125], v85 offset:20480
    ds_read_b64_tr_b16 v[126:127], v85 offset:23040
    ds_read_b64_tr_b16 v[156:157], v85 offset:20512
    ds_read_b64_tr_b16 v[158:159], v85 offset:23072
    ds_read_b64_tr_b16 v[188:189], v85 offset:20608
    ds_read_b64_tr_b16 v[190:191], v85 offset:23168
    ds_read_b64_tr_b16 v[220:221], v85 offset:20640
    ds_read_b64_tr_b16 v[222:223], v85 offset:23200
    ds_read_b64_tr_b16 v[252:253], v79 offset:20736
    ds_read_b64_tr_b16 v[254:255], v79 offset:23296
    s_waitcnt lgkmcnt(0)
    s_cmp_lg_u32 s3, 2
    s_cbranch_scc1 L_prep
    s_cmp_lt_u32 s2, 166
    s_cbranch_scc1 L_prep
    s_sub_u32 s12, 255, s2
    s_mul_i32 s68, s12, 205
    s_lshr_b32 s68, s68, 11
    s_mul_i32 s13, s68, 10
    s_sub_u32 s69, s12, s13
    v_lshrrev_b32 v26, 3, v0
    v_mul_u32_u24 v26, 1280, v26
    v_and_b32 v27, 7, v0
    v_lshl_add_u32 v26, v27, 4, v26
    s_mul_i32 s10, s68, 245760
    s_lshl_b32 s12, s69, 7
    s_add_u32 s10, s10, s12
    s_mov_b32 s48, s32
    s_mov_b32 s49, s33
    s_mov_b32 s50, 0x21c000
    s_mov_b32 s51, 0x00020000
    s_mov_b32 m0, 12800
    s_nop 0
    buffer_load_dwordx4 v26, s[48:51], s10 offen nt lds
    s_add_u32 m0, m0, 0x400
    s_add_u32 s10, s10, 10240
    buffer_load_dwordx4 v26, s[48:51], s10 offen nt lds
    s_add_u32 m0, m0, 0x400
    s_add_u32 s10, s10, 10240
    buffer_load_dwordx4 v26, s[48:51], s10 offen nt lds
    s_add_u32 m0, m0, 0x400
    s_add_u32 s10, s10, 10240
    buffer_load_dwordx4 v26, s[48:51], s10 offen nt lds
    s_add_u32 m0, m0, 0x400
    s_add_u32 s10, s10, 10240
    buffer_load_dwordx4 v26, s[48:51], s10 offen nt lds
    s_add_u32 m0, m0, 0x400
    s_add_u32 s10, s10, 10240
    buffer_load_dwordx4 v26, s[48:51], s10 offen nt lds
    s_add_u32 m0, m0, 0x400
    s_add_u32 s10, s10, 10240
    buffer_load_dwordx4 v26, s[48:51], s10 offen nt lds
    s_add_u32 m0, m0, 0x400
    s_add_u32 s10, s10, 10240
    buffer_load_dwordx4 v26, s[48:51], s10 offen nt lds
    s_add_u32 m0, m0, 0x400
    s_add_u32 s10, s10, 10240
    buffer_load_dwordx4 v26, s[48:51], s10 offen nt lds
    s_add_u32 m0, m0, 0x400
    s_add_u32 s10, s10, 10240
    buffer_load_dwordx4 v26, s[48:51], s10 offen nt lds
    s_add_u32 m0, m0, 0x400
    s_add_u32 s10, s10, 10240
    buffer_load_dwordx4 v26, s[48:51], s10 offen nt lds
    s_add_u32 m0, m0, 0x400
    s_add_u32 s10, s10, 10240
    buffer_load_dwordx4 v26, s[48:51], s10 offen nt lds
    s_add_u32 m0, m0, 0x400
    s_add_u32 s10, s10, 10240
    s_waitcnt vmcnt(11)
    buffer_load_dwordx4 v26, s[48:51], s10 offen nt lds
    s_add_u32 m0, m0, 0x400
    s_add_u32 s10, s10, 10240
    s_waitcnt vmcnt(11)
    buffer_load_dwordx4 v26, s[48:51], s10 offen nt lds
    s_add_u32 m0, m0, 0x400
    s_add_u32 s10, s10, 10240
    s_waitcnt vmcnt(11)
    buffer_load_dwordx4 v26, s[48:51], s10 offen nt lds
    s_add_u32 m0, m0, 0x400
    s_add_u32 s10, s10, 10240
    s_waitcnt vmcnt(11)
    buffer_load_dwordx4 v26, s[48:51], s10 offen nt lds
    s_add_u32 m0, m0, 0x400
    s_add_u32 s10, s10, 10240
    s_waitcnt vmcnt(11)
    buffer_load_dwordx4 v26, s[48:51], s10 offen nt lds
    s_add_u32 m0, m0, 0x400
    s_add_u32 s10, s10, 10240
    s_waitcnt vmcnt(11)
    buffer_load_dwordx4 v26, s[48:51], s10 offen nt lds
    s_add_u32 m0, m0, 0x400
    s_add_u32 s10, s10, 10240
    s_waitcnt vmcnt(11)
    buffer_load_dwordx4 v26, s[48:51], s10 offen nt lds
    s_add_u32 m0, m0, 0x400
    s_add_u32 s10, s10, 10240
    s_waitcnt vmcnt(11)
    buffer_load_dwordx4 v26, s[48:51], s10 offen nt lds
    s_add_u32 m0, m0, 0x400
    s_add_u32 s10, s10, 10240
    s_waitcnt vmcnt(11)
    buffer_load_dwordx4 v26, s[48:51], s10 offen nt lds
    s_add_u32 m0, m0, 0x400
    s_add_u32 s10, s10, 10240
    s_waitcnt vmcnt(11)
    buffer_load_dwordx4 v26, s[48:51], s10 offen nt lds
    s_add_u32 m0, m0, 0x400
    s_add_u32 s10, s10, 10240
    s_waitcnt vmcnt(11)
    buffer_load_dwordx4 v26, s[48:51], s10 offen nt lds
    s_add_u32 m0, m0, 0x400
    s_add_u32 s10, s10, 10240
    s_waitcnt vmcnt(11)
    buffer_load_dwordx4 v26, s[48:51], s10 offen nt lds
    v_cmp_le_u32 vcc, 24, v0
    v_mov_b32 v28, 24
    v_mov_b32 v29, 128
    v_cndmask_b32 v28, 0, v28, vcc
    v_cndmask_b32 v29, 0, v29, vcc
    v_sub_u32 v28, v0, v28
    v_min_u32 v28, 23, v28
    v_and_b32 v31, 7, v28
    v_lshl_add_u32 v29, v31, 4, v29
    v_lshrrev_b32 v31, 3, v28
    v_lshl_add_u32 v29, v31, 9, v29
    v_mov_b32 v30, 192
    v_cndmask_b32 v30, 0, v30, vcc
    v_lshl_add_u32 v30, v28, 3, v30
    s_mul_i32 s11, s68, 3072
    s_add_u32 s11, s11, 0xf0000
    s_add_u32 s70, s11, 27648
    s_add_u32 s71, s11, 55296
    s_add_u32 s73, s11, 82944
    v_lshlrev_b32 v28, 10, v24
    v_lshrrev_b32 v27, 2, v25
    v_lshl_add_u32 v28, v27, 7, v28
    v_and_b32 v27, 3, v0
    v_lshl_add_u32 v28, v27, 3, v28
    v_mul_u32_u24 v27, 192, v27
    v_lshl_add_u32 v27, v24, 4, v27
    ds_read_b32 v94, v95 offset:10920
    v_mov_b32 v8, 0
    v_mov_b32 v9, 0
    v_mov_b32 v10, 0
    v_mov_b32 v11, 0
    v_mov_b32 v12, 0
    v_mov_b32 v13, 0
    v_mov_b32 v14, 0
    v_mov_b32 v15, 0
    v_mov_b32 v16, 0
    v_mov_b32 v17, 0
    v_mov_b32 v18, 0
    v_mov_b32 v19, 0
    v_mov_b32 v20, 0
    v_mov_b32 v21, 0
    v_mov_b32 v22, 0
    v_mov_b32 v23, 0
    s_waitcnt lgkmcnt(0)
    v_readfirstlane_b32 s12, v94
    s_mov_b32 s64, s12
    s_lshr_b32 s65, s12, 10
    s_lshr_b32 s66, s12, 20
    s_not_b32 s67, s12
    s_lshl_b32 s67, s67, 2
    s_lshr_b32 s12, s12, 30
    s_or_b32 s67, s67, s12
    s_mov_b32 s75, 0
L_wd:
    s_mov_b32 exec_hi, 0xffff
    s_mov_b64 s[4:5], exec
L_yp45:
    buffer_load_dwordx4 v[40:43], v29, s[52:55], s11 offen offset:0 sc1
    buffer_load_dwordx4 v[44:47], v29, s[52:55], s70 offen offset:0 sc1
    buffer_load_dwordx4 v[48:51], v29, s[52:55], s71 offen offset:0 sc1
    buffer_load_dwordx4 v[52:55], v29, s[52:55], s73 offen offset:0 sc1
    buffer_load_dwordx4 v[56:59], v29, s[52:55], s11 offen offset:256 sc1
    buffer_load_dwordx4 v[60:63], v29, s[52:55], s70 offen offset:256 sc1
    buffer_load_dwordx4 v[64:67], v29, s[52:55], s71 offen offset:256 sc1
    buffer_load_dwordx4 v[68:71], v29, s[52:55], s73 offen offset:256 sc1
    s_waitcnt vmcnt(0)
    v_xor_b32 v31, s64, v40
    v_xor_b32 v32, s65, v41
    v_or_b32 v31, v31, v32
    v_xor_b32 v32, s66, v42
    v_xor_b32 v33, s67, v43
    v_or3_b32 v31, v31, v32, v33
    v_xor_b32 v32, s64, v44
    v_xor_b32 v33, s65, v45
    v_or3_b32 v31, v31, v32, v33
    v_xor_b32 v32, s66, v46
    v_xor_b32 v33, s67, v47
    v_or3_b32 v31, v31, v32, v33
    v_xor_b32 v32, s64, v48
    v_xor_b32 v33, s65, v49
    v_or3_b32 v31, v31, v32, v33
    v_xor_b32 v32, s66, v50
    v_xor_b32 v33, s67, v51
    v_or3_b32 v31, v31, v32, v33
    v_xor_b32 v32, s64, v52
    v_xor_b32 v33, s65, v53
    v_or3_b32 v31, v31, v32, v33
    v_xor_b32 v32, s66, v54
    v_xor_b32 v33, s67, v55
    v_or3_b32 v31, v31, v32, v33
    v_xor_b32 v32, s64, v56
    v_xor_b32 v33, s65, v57
    v_or3_b32 v31, v31, v32, v33
    v_xor_b32 v32, s66, v58
    v_xor_b32 v33, s67, v59
    v_or3_b32 v31, v31, v32, v33
    v_xor_b32 v32, s64, v60
    v_xor_b32 v33, s65, v61
    v_or3_b32 v31, v31, v32, v33
    v_xor_b32 v32, s66, v62
    v_xor_b32 v33, s67, v63
    v_or3_b32 v31, v31, v32, v33
    v_xor_b32 v32, s64, v64
    v_xor_b32 v33, s65, v65
    v_or3_b32 v31, v31, v32, v33
    v_xor_b32 v32, s66, v66
    v_xor_b32 v33, s67, v67
    v_or3_b32 v31, v31, v32, v33
    v_xor_b32 v32, s64, v68
    v_xor_b32 v33, s65, v69
    v_or3_b32 v31, v31, v32, v33
    v_xor_b32 v32, s66, v70
    v_xor_b32 v33, s67, v71
    v_or3_b32 v31, v31, v32, v33
    v_and_b32 v31, 0x3ff, v31
    v_cmp_ne_u32 vcc, 0, v31
    s_cbranch_vccz L_yp46
    s_add_u32 s72, s72, 1
    s_cmp_gt_u32 s72, 400000
    s_cbranch_scc1 L_yp46
    s_mov_b64 exec, vcc
    s_sleep 16
    s_branch L_yp45
L_yp46:
    s_mov_b64 exec, s[4:5]
    v_and_b32 v40, 0xfffffc00, v40
    v_and_b32 v41, 0xfffffc00, v41
    v_and_b32 v42, 0xfffffc00, v42
    v_and_b32 v43, 0xfffffc00, v43
    v_and_b32 v44, 0xfffffc00, v44
    v_and_b32 v45, 0xfffffc00, v45
    v_and_b32 v46, 0xfffffc00, v46
    v_and_b32 v47, 0xfffffc00, v47
    v_and_b32 v48, 0xfffffc00, v48
    v_and_b32 v49, 0xfffffc00, v49
    v_and_b32 v50, 0xfffffc00, v50
    v_and_b32 v51, 0xfffffc00, v51
    v_and_b32 v52, 0xfffffc00, v52
    v_and_b32 v53, 0xfffffc00, v53
    v_and_b32 v54, 0xfffffc00, v54
    v_and_b32 v55, 0xfffffc00, v55
    v_and_b32 v56, 0xfffffc00, v56
    v_and_b32 v57, 0xfffffc00, v57
    v_and_b32 v58, 0xfffffc00, v58
    v_and_b32 v59, 0xfffffc00, v59
    v_and_b32 v60, 0xfffffc00, v60
    v_and_b32 v61, 0xfffffc00, v61
    v_and_b32 v62, 0xfffffc00, v62
    v_and_b32 v63, 0xfffffc00, v63
    v_and_b32 v64, 0xfffffc00, v64
    v_and_b32 v65, 0xfffffc00, v65
    v_and_b32 v66, 0xfffffc00, v66
    v_and_b32 v67, 0xfffffc00, v67
    v_and_b32 v68, 0xfffffc00, v68
    v_and_b32 v69, 0xfffffc00, v69
    v_and_b32 v70, 0xfffffc00, v70
    v_and_b32 v71, 0xfffffc00, v71
    v_add_f32 v40, v40, v44
    v_add_f32 v48, v48, v52
    v_add_f32 v41, v41, v45
    v_add_f32 v49, v49, v53
    v_add_f32 v42, v42, v46
    v_add_f32 v50, v50, v54
    v_add_f32 v43, v43, v47
    v_add_f32 v51, v51, v55
    v_cvt_pk_bf16_f32 v44, v40, v41
    v_cvt_pk_bf16_f32 v52, v48, v49
    v_cvt_pk_bf16_f32 v45, v42, v43
    v_cvt_pk_bf16_f32 v53, v50, v51
    v_lshlrev_b32 v31, 16, v44
    v_and_b32 v32, 0xffff0000, v44
    v_lshlrev_b32 v33, 16, v52
    v_and_b32 v34, 0xffff0000, v52
    v_mul_f32 v31, v31, v33
    v_mul_f32 v32, v32, v34
    v_cvt_pk_bf16_f32 v40, v31, v32
    v_lshlrev_b32 v31, 16, v45
    v_and_b32 v32, 0xffff0000, v45
    v_lshlrev_b32 v33, 16, v53
    v_and_b32 v34, 0xffff0000, v53
    v_mul_f32 v31, v31, v33
    v_mul_f32 v32, v32, v34
    v_cvt_pk_bf16_f32 v41, v31, v32
    ds_write_b64 v30, v[40:41] offset:11904
    v_add_f32 v56, v56, v60
    v_add_f32 v64, v64, v68
    v_add_f32 v57, v57, v61
    v_add_f32 v65, v65, v69
    v_add_f32 v58, v58, v62
    v_add_f32 v66, v66, v70
    v_add_f32 v59, v59, v63
    v_add_f32 v67, v67, v71
    v_cvt_pk_bf16_f32 v60, v56, v57
    v_cvt_pk_bf16_f32 v68, v64, v65
    v_cvt_pk_bf16_f32 v61, v58, v59
    v_cvt_pk_bf16_f32 v69, v66, v67
    v_lshlrev_b32 v31, 16, v60
    v_and_b32 v32, 0xffff0000, v60
    v_lshlrev_b32 v33, 16, v68
    v_and_b32 v34, 0xffff0000, v68
    v_mul_f32 v31, v31, v33
    v_mul_f32 v32, v32, v34
    v_cvt_pk_bf16_f32 v56, v31, v32
    v_lshlrev_b32 v31, 16, v61
    v_and_b32 v32, 0xffff0000, v61
    v_lshlrev_b32 v33, 16, v69
    v_and_b32 v34, 0xffff0000, v69
    v_mul_f32 v31, v31, v33
    v_mul_f32 v32, v32, v34
    v_cvt_pk_bf16_f32 v57, v31, v32
    ds_write_b64 v30, v[56:57] offset:12288
    s_mov_b64 exec, -1
    s_waitcnt lgkmcnt(0)
    ds_read_b128 v[64:67], v27 offset:11904
    ds_read_b128 v[68:71], v27 offset:11968
    ds_read_b128 v[72:75], v27 offset:12032
    ds_read_b64_tr_b16 v[48:49], v28 offset:12800
    ds_read_b64_tr_b16 v[50:51], v28 offset:13312
    ds_read_b64_tr_b16 v[52:53], v28 offset:12832
    ds_read_b64_tr_b16 v[54:55], v28 offset:13344
    ds_read_b64_tr_b16 v[56:57], v28 offset:12864
    ds_read_b64_tr_b16 v[58:59], v28 offset:13376
    ds_read_b64_tr_b16 v[60:61], v28 offset:12896
    ds_read_b64_tr_b16 v[62:63], v28 offset:13408
    s_waitcnt lgkmcnt(0)
    v_mfma_f32_16x16x32_bf16 v[8:11], v[48:51], v[64:67], v[8:11]
    v_mfma_f32_16x16x32_bf16 v[12:15], v[52:55], v[64:67], v[12:15]
    v_mfma_f32_16x16x32_bf16 v[16:19], v[56:59], v[64:67], v[16:19]
    v_mfma_f32_16x16x32_bf16 v[20:23], v[60:63], v[64:67], v[20:23]
    s_nop 7
    ds_read_b64_tr_b16 v[48:49], v28 offset:16896
    ds_read_b64_tr_b16 v[50:51], v28 offset:17408
    ds_read_b64_tr_b16 v[52:53], v28 offset:16928
    ds_read_b64_tr_b16 v[54:55], v28 offset:17440
    ds_read_b64_tr_b16 v[56:57], v28 offset:16960
    ds_read_b64_tr_b16 v[58:59], v28 offset:17472
    ds_read_b64_tr_b16 v[60:61], v28 offset:16992
    ds_read_b64_tr_b16 v[62:63], v28 offset:17504
    s_waitcnt lgkmcnt(0)
    v_mfma_f32_16x16x32_bf16 v[8:11], v[48:51], v[68:71], v[8:11]
    v_mfma_f32_16x16x32_bf16 v[12:15], v[52:55], v[68:71], v[12:15]
    v_mfma_f32_16x16x32_bf16 v[16:19], v[56:59], v[68:71], v[16:19]
    v_mfma_f32_16x16x32_bf16 v[20:23], v[60:63], v[68:71], v[20:23]
    s_nop 7
    ds_read_b64_tr_b16 v[48:49], v28 offset:20992
    ds_read_b64_tr_b16 v[50:51], v28 offset:21504
    ds_read_b64_tr_b16 v[52:53], v28 offset:21024
    ds_read_b64_tr_b16 v[54:55], v28 offset:21536
    ds_read_b64_tr_b16 v[56:57], v28 offset:21056
    ds_read_b64_tr_b16 v[58:59], v28 offset:21568
    ds_read_b64_tr_b16 v[60:61], v28 offset:21088
    ds_read_b64_tr_b16 v[62:63], v28 offset:21600
    s_waitcnt lgkmcnt(0)
    v_mfma_f32_16x16x32_bf16 v[8:11], v[48:51], v[72:75], v[8:11]
    v_mfma_f32_16x16x32_bf16 v[12:15], v[52:55], v[72:75], v[12:15]
    v_mfma_f32_16x16x32_bf16 v[16:19], v[56:59], v[72:75], v[16:19]
    v_mfma_f32_16x16x32_bf16 v[20:23], v[60:63], v[72:75], v[20:23]
    s_nop 7
    v_add_u32 v28, 12288, v28
    v_add_u32 v29, 1536, v29
    s_add_u32 s75, s75, 1
    s_cmp_lt_u32 s75, 2
    s_cbranch_scc1 L_wd
    v_bfe_u32 v30, v0, 3, 1
    v_lshlrev_b32 v30, 2, v30
    v_and_b32 v31, 3, v0
    v_add_u32 v30, v30, v31
    v_lshlrev_b32 v30, 7, v30
    v_bfe_u32 v31, v0, 2, 1
    v_lshl_add_u32 v30, v31, 6, v30
    v_lshl_add_u32 v30, v24, 4, v30
    s_sub_u32 s10, 255, s2
    s_lshl_b32 s10, s10, 10
    s_add_u32 s10, s10, 0xa0000
    s_nop 3
    v_mov_b32_dpp v8, v12 row_shr:4 row_mask:0xf bank_mask:0x2
    v_mov_b32_dpp v9, v13 row_shr:4 row_mask:0xf bank_mask:0x2
    v_mov_b32_dpp v10, v14 row_shr:4 row_mask:0xf bank_mask:0x2
    v_mov_b32_dpp v11, v15 row_shr:4 row_mask:0xf bank_mask:0x2
    v_mov_b32_dpp v8, v16 row_shr:8 row_mask:0xf bank_mask:0x4
    v_mov_b32_dpp v9, v17 row_shr:8 row_mask:0xf bank_mask:0x4
    v_mov_b32_dpp v10, v18 row_shr:8 row_mask:0xf bank_mask:0x4
    v_mov_b32_dpp v11, v19 row_shr:8 row_mask:0xf bank_mask:0x4
    v_mov_b32_dpp v8, v20 row_shr:12 row_mask:0xf bank_mask:0x8
    v_mov_b32_dpp v9, v21 row_shr:12 row_mask:0xf bank_mask:0x8
    v_mov_b32_dpp v10, v22 row_shr:12 row_mask:0xf bank_mask:0x8
    v_mov_b32_dpp v11, v23 row_shr:12 row_mask:0xf bank_mask:0x8
    v_add_u32 v8, 0x200, v8
    v_add_u32 v9, 0x200, v9
    v_add_u32 v10, 0x200, v10
    v_add_u32 v11, 0x200, v11
    v_bfi_b32 v8, v93, s64, v8
    v_bfi_b32 v9, v93, s65, v9
    v_bfi_b32 v10, v93, s66, v10
    v_bfi_b32 v11, v93, s67, v11
    buffer_store_dwordx4 v[8:11], v30, s[52:55], s10 offen sc1
    s_waitcnt vmcnt(0)
L_prep:
    ds_read_b32 v94, v95 offset:10920
    v_and_b32 v26, 3, v0
    v_bfe_u32 v27, v0, 2, 1
    v_lshl_add_u32 v26, v26, 1, v27
    v_mul_u32_u24 v9, 272, v26
    v_lshl_add_u32 v9, v24, 4, v9
    s_mul_i32 s12, s3, 640
    v_lshlrev_b32 v10, 2, v0
    v_add_u32 v10, s12, v10
    s_waitcnt lgkmcnt(0)
    v_readfirstlane_b32 s12, v94
    v_mov_b32 v62, v94
    v_xor_b32 v63, 0x9e3779b9, v94
    s_mov_b32 s64, s12
    s_lshr_b32 s65, s12, 10
    s_lshr_b32 s66, s12, 20
    s_not_b32 s67, s12
    s_lshl_b32 s67, s67, 2
    s_lshr_b32 s12, s12, 30
    s_or_b32 s67, s67, s12
    v_and_b32 v26, 3, v0
    v_mov_b32 v11, s64
    v_mov_b32 v27, s65
    v_cmp_eq_u32 vcc, 1, v26
    s_nop 1
    v_cndmask_b32 v11, v11, v27, vcc
    v_mov_b32 v27, s66
    v_cmp_eq_u32 vcc, 2, v26
    s_nop 1
    v_cndmask_b32 v11, v11, v27, vcc
    v_mov_b32 v27, s67
    v_cmp_eq_u32 vcc, 3, v26
    s_nop 1
    v_cndmask_b32 v11, v11, v27, vcc
    s_lshl_b32 s11, s9, 1
    s_add_u32 s11, s11, s8
    s_mul_i32 s11, s11, 2560
    s_and_b32 s15, s2, 3
    s_lshl_b32 s15, s15, 2
    s_add_u32 s15, s15, s3
    s_mul_i32 s15, s15, 40960
    s_lshr_b32 s13, s2, 2
    s_lshl_b32 s13, s13, 7
    s_add_u32 s15, s15, s13
    s_add_u32 s14, s15, 20480
    v_and_b32 v86, 7, v0
    v_lshlrev_b32 v86, 4, v86
    v_bfe_u32 v87, v0, 4, 1
    v_lshl_add_u32 v86, v87, 3, v86
    v_lshrrev_b32 v87, 5, v0
    v_lshl_add_u32 v86, v87, 2, v86
    v_lshrrev_b32 v87, 3, v0
    v_mul_u32_u24 v87, 2560, v87
    v_and_b32 v28, 7, v0
    v_lshl_add_u32 v87, v28, 4, v87
    s_waitcnt vmcnt(0)
    s_cmp_lg_u32 s3, 0
    s_cbranch_scc1 L_h8
    v_and_b32 v12, 3, v0
    v_lshlrev_b32 v13, 2, v12
    v_lshlrev_b32 v12, 3, v12
    s_and_b32 s10, s2, 127
    s_lshl_b32 s10, s10, 7
    s_add_u32 s10, s10, 0x10c000
    s_lshl_b32 s13, s8, 6
    s_add_u32 s68, s10, s13
    s_xor_b32 s69, s68, 64
L_lw47:
    ds_read_b32 v94, v95 offset:10912
    s_waitcnt lgkmcnt(0)
    v_readfirstlane_b32 s12, v94
    s_cmp_ge_u32 s12, 4
    s_cbranch_scc1 L_lw48
    s_add_u32 s72, s72, 1
    s_cmp_gt_u32 s72, 400000
    s_cbranch_scc1 L_lw48
    s_sleep 4
    s_branch L_lw47
L_lw48:
    s_memrealtime s[4:5]
    ds_read_b64 v[14:15], v12 offset:10880
    s_waitcnt lgkmcnt(0)
    v_mov_b32 v60, v14
    s_nop 1
    v_max_f32_dpp v60, v60, v60 quad_perm:[1,0,3,2] row_mask:0xf bank_mask:0xf
    s_nop 1
    v_max_f32_dpp v60, v60, v60 quad_perm:[2,3,0,1] row_mask:0xf bank_mask:0xf
    v_sub_f32 v16, v14, v60
    v_mul_f32 v16, 0x3fb8aa3b, v16
    v_exp_f32 v16, v16
    s_nop 0
    v_mul_f32 v61, v16, v15
    s_nop 1
    v_add_f32_dpp v61, v61, v61 quad_perm:[1,0,3,2] row_mask:0xf bank_mask:0xf
    s_nop 1
    v_add_f32_dpp v61, v61, v61 quad_perm:[2,3,0,1] row_mask:0xf bank_mask:0xf
    v_mov_b32 v44, v60
    v_mov_b32 v45, v61
    v_mov_b32 v46, v62
    v_mov_b32 v47, v63
    s_mov_b64 exec, 2
    v_mov_b32 v44, s4
    s_mov_b64 exec, 3
    buffer_store_dwordx4 v[44:47], v2, s[52:55], s68 offen sc1
    s_mov_b64 exec, -1
    s_waitcnt vmcnt(0)
L_tp49:
    buffer_load_dwordx4 v[40:43], off, s[52:55], s69 sc1
    s_waitcnt vmcnt(0)
    v_xor_b32 v42, v42, v62
    v_xor_b32 v43, v43, v63
    v_or_b32 v42, v42, v43
    v_cmp_ne_u32 vcc, 0, v42
    s_cbranch_vccz L_tp50
    s_add_u32 s72, s72, 1
    s_cmp_gt_u32 s72, 400000
    s_cbranch_scc1 L_tp50
    s_mov_b64 exec, vcc
    s_sleep 32
    s_branch L_tp49
L_tp50:
    s_mov_b64 exec, -1
    v_max_f32 v17, v60, v40
    v_sub_f32 v60, v60, v17
    v_sub_f32 v40, v40, v17
    v_sub_f32 v14, v14, v17
    v_mul_f32 v60, 0x3fb8aa3b, v60
    v_mul_f32 v40, 0x3fb8aa3b, v40
    v_mul_f32 v14, 0x3fb8aa3b, v14
    v_exp_f32 v60, v60
    v_exp_f32 v40, v40
    v_exp_f32 v14, v14
    v_mul_f32 v61, v60, v61
    v_fmac_f32 v61, v40, v41
    v_rcp_f32 v61, v61
    s_nop 0
    v_mul_f32 v14, v14, v61
    ds_write_b32 v13, v14 offset:10944
    v_lshrrev_b32 v48, 1, v0
    v_mul_u32_u24 v49, 5, v48
    s_lshr_b32 s13, s2, 3
    s_add_u32 s13, s13, 3
    v_add_u32 v49, s13, v49
    v_and_b32 v49, 15, v49
    v_lshl_add_u32 v48, v49, 3, v48
    v_lshlrev_b32 v48, 7, v48
    v_and_b32 v49, 1, v0
    v_lshl_add_u32 v48, v49, 6, v48
    s_mov_b32 s10, 0x10c010
    s_mov_b64 exec, 0xffff
L_tp51:
    buffer_load_dwordx4 v[40:43], v48, s[52:55], s10 offen sc1
    s_waitcnt vmcnt(0)
    v_xor_b32 v42, v42, v62
    v_xor_b32 v43, v43, v63
    v_or_b32 v42, v42, v43
    v_cmp_ne_u32 vcc, 0, v42
    s_cbranch_vccz L_tp52
    s_add_u32 s72, s72, 1
    s_cmp_gt_u32 s72, 400000
    s_cbranch_scc1 L_tp52
    s_mov_b64 exec, vcc
    s_sleep 32
    s_branch L_tp51
L_tp52:
    s_mov_b64 exec, -1
    v_subrev_u32 v40, s4, v40
    v_cvt_f32_i32 v40, v40
    s_nop 1
    v_add_f32_dpp v40, v40, v40 row_ror:8 row_mask:0xf bank_mask:0xf
    s_nop 1
    v_add_f32_dpp v40, v40, v40 row_ror:4 row_mask:0xf bank_mask:0xf
    s_nop 1
    v_add_f32_dpp v40, v40, v40 row_ror:2 row_mask:0xf bank_mask:0xf
    s_nop 1
    v_add_f32_dpp v40, v40, v40 row_ror:1 row_mask:0xf bank_mask:0xf
    v_mul_f32 v40, 0.0625, v40
    v_cvt_i32_f32 v40, v40
    s_sub_u32 s4, s4, 940
    v_add_u32 v40, s4, v40
    v_or_b32 v40, 1, v40
    s_mov_b64 exec, 1
    ds_write_b32 v95, v40 offset:10932
    s_mov_b64 exec, -1
    s_waitcnt lgkmcnt(0)
L_h8:
    s_sub_u32 s12, s3, 1
    s_cmp_lt_u32 s12, 2
    s_cbranch_scc1 L_nc
L_fw53:
    ds_read_b64 v[80:81], v95 offset:11664
    s_waitcnt lgkmcnt(0)
    v_min_u32 v80, v80, v81
    s_nop 0
    v_readfirstlane_b32 s12, v80
    s_cmp_ge_u32 s12, 5
    s_cbranch_scc1 L_fw54
    s_add_u32 s72, s72, 1
    s_cmp_gt_u32 s72, 400000
    s_cbranch_scc1 L_fw54
    s_sleep 8
    s_branch L_fw53
L_fw54:
    ds_read_b64_tr_b16 v[112:113], v84 offset:0
    ds_read_b64_tr_b16 v[114:115], v84 offset:2560
    ds_read_b64_tr_b16 v[144:145], v84 offset:32
    ds_read_b64_tr_b16 v[146:147], v84 offset:2592
    ds_read_b64_tr_b16 v[176:177], v84 offset:128
    ds_read_b64_tr_b16 v[178:179], v84 offset:2688
    ds_read_b64_tr_b16 v[208:209], v84 offset:160
    ds_read_b64_tr_b16 v[210:211], v84 offset:2720
    ds_read_b64_tr_b16 v[240:241], v78 offset:256
    ds_read_b64_tr_b16 v[242:243], v78 offset:2816
    s_waitcnt lgkmcnt(0)
L_fw55:
    ds_read_b64 v[80:81], v95 offset:11664
    s_waitcnt lgkmcnt(0)
    v_min_u32 v80, v80, v81
    s_nop 0
    v_readfirstlane_b32 s12, v80
    s_cmp_ge_u32 s12, 6
    s_cbranch_scc1 L_fw56
    s_add_u32 s72, s72, 1
    s_cmp_gt_u32 s72, 400000
    s_cbranch_scc1 L_fw56
    s_sleep 8
    s_branch L_fw55
L_fw56:
    ds_read_b64_tr_b16 v[116:117], v84 offset:20480
    ds_read_b64_tr_b16 v[118:119], v84 offset:23040
    ds_read_b64_tr_b16 v[148:149], v84 offset:20512
    ds_read_b64_tr_b16 v[150:151], v84 offset:23072
    ds_read_b64_tr_b16 v[180:181], v84 offset:20608
    ds_read_b64_tr_b16 v[182:183], v84 offset:23168
    ds_read_b64_tr_b16 v[212:213], v84 offset:20640
    ds_read_b64_tr_b16 v[214:215], v84 offset:23200
    ds_read_b64_tr_b16 v[244:245], v78 offset:20736
    ds_read_b64_tr_b16 v[246:247], v78 offset:23296
    s_waitcnt lgkmcnt(0)
L_fw57:
    ds_read_b64 v[80:81], v95 offset:11664
    s_waitcnt lgkmcnt(0)
    v_min_u32 v80, v80, v81
    s_nop 0
    v_readfirstlane_b32 s12, v80
    s_cmp_ge_u32 s12, 7
    s_cbranch_scc1 L_fw58
    s_add_u32 s72, s72, 1
    s_cmp_gt_u32 s72, 400000
    s_cbranch_scc1 L_fw58
    s_sleep 8
    s_branch L_fw57
L_fw58:
    ds_read_b64_tr_b16 v[120:121], v85 offset:0
    ds_read_b64_tr_b16 v[122:123], v85 offset:2560
    ds_read_b64_tr_b16 v[152:153], v85 offset:32
    ds_read_b64_tr_b16 v[154:155], v85 offset:2592
    ds_read_b64_tr_b16 v[184:185], v85 offset:128
    ds_read_b64_tr_b16 v[186:187], v85 offset:2688
    ds_read_b64_tr_b16 v[216:217], v85 offset:160
    ds_read_b64_tr_b16 v[218:219], v85 offset:2720
    ds_read_b64_tr_b16 v[248:249], v79 offset:256
    ds_read_b64_tr_b16 v[250:251], v79 offset:2816
    s_waitcnt lgkmcnt(0)
L_fw59:
    ds_read_b64 v[80:81], v95 offset:11664
    s_waitcnt lgkmcnt(0)
    v_min_u32 v80, v80, v81
    s_nop 0
    v_readfirstlane_b32 s12, v80
    s_cmp_ge_u32 s12, 8
    s_cbranch_scc1 L_fw60
    s_add_u32 s72, s72, 1
    s_cmp_gt_u32 s72, 400000
    s_cbranch_scc1 L_fw60
    s_sleep 8
    s_branch L_fw59
L_fw60:
    ds_read_b64_tr_b16 v[124:125], v85 offset:20480
    ds_read_b64_tr_b16 v[126:127], v85 offset:23040
    ds_read_b64_tr_b16 v[156:157], v85 offset:20512
    ds_read_b64_tr_b16 v[158:159], v85 offset:23072
    ds_read_b64_tr_b16 v[188:189], v85 offset:20608
    ds_read_b64_tr_b16 v[190:191], v85 offset:23168
    ds_read_b64_tr_b16 v[220:221], v85 offset:20640
    ds_read_b64_tr_b16 v[222:223], v85 offset:23200
    ds_read_b64_tr_b16 v[252:253], v79 offset:20736
    ds_read_b64_tr_b16 v[254:255], v79 offset:23296
    s_waitcnt lgkmcnt(0)
    s_cmp_ge_u32 s2, 80
    s_cbranch_scc1 L_nc
    s_cmp_lg_u32 s3, 3
    s_cbranch_scc1 L_nc
    s_lshr_b32 s13, s2, 3
    v_lshrrev_b32 v30, 3, v0
    v_and_b32 v29, 7, v0
    v_lshlrev_b32 v29, 4, v29
    v_add_u32 v31, 0, v30
    v_mul_u32_u24 v31, 10240, v31
    v_add_u32 v36, v31, v29
    v_add_u32 v31, 8, v30
    v_min_u32 v31, 8, v31
    v_mul_u32_u24 v31, 10240, v31
    v_add_u32 v37, v31, v29
    s_lshl_b32 s10, s2, 7
    s_add_u32 s10, s10, 0xa0000
L_lw61:
    ds_read_b32 v94, v95 offset:10924
    s_waitcnt lgkmcnt(0)
    v_readfirstlane_b32 s12, v94
    s_cmp_ge_u32 s12, 36
    s_cbranch_scc1 L_lw62
    s_add_u32 s72, s72, 1
    s_cmp_gt_u32 s72, 400000
    s_cbranch_scc1 L_lw62
    s_sleep 16
    s_branch L_lw61
L_lw62:
L_yp63:
    buffer_load_dwordx4 v[40:43], v36, s[52:55], s10 offen sc1
    buffer_load_dwordx4 v[44:47], v37, s[52:55], s10 offen sc1
    s_waitcnt vmcnt(0)
    v_xor_b32 v52, s64, v40
    v_xor_b32 v53, s65, v41
    v_or_b32 v52, v52, v53
    v_xor_b32 v53, s66, v42
    v_xor_b32 v54, s67, v43
    v_or3_b32 v52, v52, v53, v54
    v_xor_b32 v53, s64, v44
    v_xor_b32 v54, s65, v45
    v_or3_b32 v52, v52, v53, v54
    v_xor_b32 v53, s66, v46
    v_xor_b32 v54, s67, v47
    v_or3_b32 v52, v52, v53, v54
    v_and_b32 v52, 0x3ff, v52
    v_cmp_ne_u32 vcc, 0, v52
    s_cbranch_vccz L_yp64
    s_add_u32 s72, s72, 1
    s_cmp_gt_u32 s72, 400000
    s_cbranch_scc1 L_yp64
    s_mov_b64 exec, vcc
    s_sleep 32
    s_branch L_yp63
L_yp64:
    s_mov_b64 exec, -1
    v_cmp_gt_u32 vcc, 8, v0
    s_nop 1
    v_cndmask_b32 v44, 0, v44, vcc
    v_cndmask_b32 v45, 0, v45, vcc
    v_cndmask_b32 v46, 0, v46, vcc
    v_cndmask_b32 v47, 0, v47, vcc
    v_add_f32 v40, v40, v44
    v_add_f32 v41, v41, v45
    v_add_f32 v42, v42, v46
    v_add_f32 v43, v43, v47
    s_nop 1
    v_permlane32_swap_b32 v40, v41
    v_permlane32_swap_b32 v42, v43
    s_nop 1
    v_add_f32 v40, v40, v41
    v_add_f32 v42, v42, v43
    s_nop 1
    v_permlane16_swap_b32 v40, v42
    s_nop 1
    v_add_f32 v40, v40, v42
    s_nop 1
    v_add_f32_dpp v40, v40, v40 row_ror:8 row_mask:0xf bank_mask:0xf
    ds_write_b32 v86, v40 offset:11520
    v_lshlrev_b32 v30, 2, v0
    v_and_b32 v30, 127, v30
    v_sub_f32 v31, 1.0, v91
    v_cvt_pk_bf16_f32 v31, v31, v31
    v_lshlrev_b32 v31, 16, v31
    s_waitcnt lgkmcnt(0)
    ds_read_b32 v92, v30 offset:11520
    s_waitcnt lgkmcnt(0)
    v_cvt_pk_bf16_f32 v92, v92, v92
    v_lshlrev_b32 v92, 16, v92
    v_mul_f32 v92, v31, v92
    v_cvt_pk_bf16_f32 v92, v92, v92
    v_lshlrev_b32 v92, 16, v92
L_nc:
    s_cmp_lg_u32 s3, 1
    s_cbranch_scc1 L_nctl
    s_and_b32 s10, s2, 127
    s_lshl_b32 s10, s10, 1
    s_add_u32 s10, s10, s8
    s_lshl_b32 s10, s10, 6
    s_add_u32 s10, s10, 0x114000
L_lw65:
    ds_read_b32 v94, v95 offset:10924
    s_waitcnt lgkmcnt(0)
    v_readfirstlane_b32 s12, v94
    s_cmp_ge_u32 s12, 36
    s_cbranch_scc1 L_lw66
    s_add_u32 s72, s72, 1
    s_cmp_gt_u32 s72, 400000
    s_cbranch_scc1 L_lw66
    s_sleep 4
    s_branch L_lw65
L_lw66:
    s_memrealtime s[4:5]
    s_waitcnt lgkmcnt(0)
    v_mov_b32 v60, s4
    v_mov_b32 v61, s4
    s_mov_b64 exec, 1
    buffer_store_dwordx4 v[60:63], off, s[52:55], s10 sc1
    s_mov_b64 exec, -1
    s_waitcnt vmcnt(0)
    v_lshrrev_b32 v48, 1, v0
    v_mul_u32_u24 v49, 5, v48
    s_lshr_b32 s13, s2, 3
    s_add_u32 s13, s13, 3
    v_add_u32 v49, s13, v49
    v_and_b32 v49, 15, v49
    v_lshl_add_u32 v48, v49, 3, v48
    v_lshlrev_b32 v48, 7, v48
    v_and_b32 v49, 1, v0
    v_lshl_add_u32 v48, v49, 6, v48
    s_mov_b32 s10, 0x114000
    s_mov_b64 exec, 0xffff
L_tp67:
    buffer_load_dwordx4 v[40:43], v48, s[52:55], s10 offen sc1
    s_waitcnt vmcnt(0)
    v_xor_b32 v42, v42, v62
    v_xor_b32 v43, v43, v63
    v_or_b32 v42, v42, v43
    v_cmp_ne_u32 vcc, 0, v42
    s_cbranch_vccz L_tp68
    s_add_u32 s72, s72, 1
    s_cmp_gt_u32 s72, 400000
    s_cbranch_scc1 L_tp68
    s_mov_b64 exec, vcc
    s_sleep 32
    s_branch L_tp67
L_tp68:
    s_mov_b64 exec, -1
    v_subrev_u32 v40, s4, v40
    v_cvt_f32_i32 v40, v40
    s_nop 1
    v_add_f32_dpp v40, v40, v40 row_ror:8 row_mask:0xf bank_mask:0xf
    s_nop 1
    v_add_f32_dpp v40, v40, v40 row_ror:4 row_mask:0xf bank_mask:0xf
    s_nop 1
    v_add_f32_dpp v40, v40, v40 row_ror:2 row_mask:0xf bank_mask:0xf
    s_nop 1
    v_add_f32_dpp v40, v40, v40 row_ror:1 row_mask:0xf bank_mask:0xf
    v_mul_f32 v40, 0.0625, v40
    v_cvt_i32_f32 v40, v40
    s_sub_u32 s4, s4, 1856
    v_add_u32 v40, s4, v40
    v_or_b32 v40, 1, v40
    s_mov_b64 exec, 1
    ds_write_b32 v95, v40 offset:10932
    s_mov_b64 exec, -1
L_nctl:
L_h9:
    s_lshl_b32 s12, s3, 7
    v_add_u32 v86, s12, v86
    s_mul_i32 s68, s3, 10240
    s_add_u32 s68, s68, 64000
    v_lshlrev_b32 v77, 2, v0
    v_add_u32 v77, s68, v77
    v_add_u32 v78, s68, v2
    s_mul_i32 s68, s3, 640
    v_add_u32 v79, s68, v2
    s_mov_b32 s68, 0x11111111
    s_mov_b32 s69, 0x11111111
    s_mov_b32 s70, 0x1111
    s_mov_b32 s71, 0x1111
    v_mov_b32 v32, 0
    v_mov_b32 v33, 0
    v_mov_b32 v34, 0
    v_mov_b32 v35, 0
    v_mov_b32 v36, 0
    v_mov_b32 v37, 0
    v_mov_b32 v38, 0
    v_mov_b32 v39, 0
    v_mov_b32 v40, 0
    v_mov_b32 v41, 0
    v_mov_b32 v42, 0
    v_mov_b32 v43, 0
    v_mov_b32 v44, 0
    v_mov_b32 v45, 0
    v_mov_b32 v46, 0
    v_mov_b32 v47, 0
    v_mov_b32 v48, 0
    v_mov_b32 v49, 0
    v_mov_b32 v50, 0
    v_mov_b32 v51, 0
    v_mov_b32 v76, 0x44444444
    v_mov_b32 v77, 0xeeeeeeee
    v_and_b32 v78, 8, v0
    v_cmp_ne_u32 vcc, 0, v78
    s_nop 1
    v_cndmask_b32 v76, v76, v77, vcc
    v_lshrrev_b32 v77, 5, v0
    v_lshlrev_b32 v77, 6, v77
    v_sub_u32 v77, v10, v77
    s_barrier
    ds_read_b128 v[12:15], v9 offset:8704
    ds_read_b128 v[16:19], v9 offset:8768
    ds_read_b128 v[20:23], v9 offset:8832
    ds_read_b128 v[24:27], v9 offset:8896
    ds_read_b128 v[72:75], v95 offset:10944
    s_waitcnt lgkmcnt(4)
    v_smfmac_f32_16x16x64_bf16 v[48:51], v[12:15], v[224:231], v76
    s_waitcnt lgkmcnt(3)
    v_smfmac_f32_16x16x64_bf16 v[48:51], v[16:19], v[232:239], v76
    s_waitcnt lgkmcnt(2)
    v_smfmac_f32_16x16x64_bf16 v[48:51], v[20:23], v[240:247], v76
    s_waitcnt lgkmcnt(1)
    v_smfmac_f32_16x16x64_bf16 v[48:51], v[24:27], v[248:255], v76
    s_waitcnt lgkmcnt(0)
    v_smfmac_f32_16x16x64_bf16 v[32:35], v[12:15], v[96:103], v76
    s_nop 2
    v_smfmac_f32_16x16x64_bf16 v[32:35], v[16:19], v[104:111], v76
    s_nop 2
    v_smfmac_f32_16x16x64_bf16 v[32:35], v[20:23], v[112:119], v76
    v_pk_mul_f32 v[48:49], v[48:49], v[72:73]
    v_pk_fma_f32 v[48:49], v[50:51], v[74:75], v[48:49]
    v_add_f32 v50, v48, v49
    v_smfmac_f32_16x16x64_bf16 v[32:35], v[24:27], v[120:127], v76
    v_add_f32 v48, v48, v49
    s_nop 1
    v_smfmac_f32_16x16x64_bf16 v[36:39], v[12:15], v[128:135], v76
    v_permlane16_swap_b32 v48, v50
    s_nop 0
    v_add_f32 v48, v48, v50
    v_smfmac_f32_16x16x64_bf16 v[36:39], v[16:19], v[136:143], v76
    v_add_u32 v48, 0x200, v48
    v_bfi_b32 v48, v93, v11, v48
    v_pk_mul_f32 v[32:33], v[32:33], v[72:73]
    v_smfmac_f32_16x16x64_bf16 v[36:39], v[20:23], v[144:151], v76
    v_mov_b32_dpp v49, v48 quad_perm:[1,1,1,1] row_mask:0xf bank_mask:0xf
    v_mov_b32_dpp v50, v48 quad_perm:[2,2,2,2] row_mask:0xf bank_mask:0xf
    v_mov_b32_dpp v51, v48 quad_perm:[3,3,3,3] row_mask:0xf bank_mask:0xf
    v_smfmac_f32_16x16x64_bf16 v[36:39], v[24:27], v[152:159], v76
    s_mov_b64 exec, s[70:71]
    buffer_store_dwordx4 v[48:51], v77, s[52:55], s11 offen offset:512 sc1
    s_mov_b64 exec, -1
    v_smfmac_f32_16x16x64_bf16 v[40:43], v[12:15], v[160:167], v76
    v_pk_fma_f32 v[32:33], v[34:35], v[74:75], v[32:33]
    v_add_f32 v32, v32, v33
    s_nop 0
    v_smfmac_f32_16x16x64_bf16 v[40:43], v[16:19], v[168:175], v76
    v_pk_mul_f32 v[36:37], v[36:37], v[72:73]
    v_pk_fma_f32 v[36:37], v[38:39], v[74:75], v[36:37]
    v_add_f32 v36, v36, v37
    v_smfmac_f32_16x16x64_bf16 v[40:43], v[20:23], v[176:183], v76
    s_nop 0
    v_permlane16_swap_b32 v32, v36
    s_nop 0
    v_smfmac_f32_16x16x64_bf16 v[40:43], v[24:27], v[184:191], v76
    v_add_f32 v32, v32, v36
    v_add_u32 v32, 0x200, v32
    v_bfi_b32 v32, v93, v11, v32
    v_smfmac_f32_16x16x64_bf16 v[44:47], v[12:15], v[192:199], v76
    s_nop 0
    v_mov_b32_dpp v33, v32 quad_perm:[1,1,1,1] row_mask:0xf bank_mask:0xf
    v_mov_b32_dpp v34, v32 quad_perm:[2,2,2,2] row_mask:0xf bank_mask:0xf
    v_smfmac_f32_16x16x64_bf16 v[44:47], v[16:19], v[200:207], v76
    v_mov_b32_dpp v35, v32 quad_perm:[3,3,3,3] row_mask:0xf bank_mask:0xf
    s_mov_b64 exec, s[68:69]
    buffer_store_dwordx4 v[32:35], v10, s[52:55], s11 offen offset:0 sc1
    s_mov_b64 exec, -1
    v_smfmac_f32_16x16x64_bf16 v[44:47], v[20:23], v[208:215], v76
    v_pk_mul_f32 v[40:41], v[40:41], v[72:73]
    v_pk_fma_f32 v[40:41], v[42:43], v[74:75], v[40:41]
    v_add_f32 v40, v40, v41
    v_smfmac_f32_16x16x64_bf16 v[44:47], v[24:27], v[216:223], v76
    s_nop 7
    v_pk_mul_f32 v[44:45], v[44:45], v[72:73]
    v_pk_fma_f32 v[44:45], v[46:47], v[74:75], v[44:45]
    v_add_f32 v44, v44, v45
    s_nop 1
    v_permlane16_swap_b32 v40, v44
    s_nop 0
    v_add_f32 v40, v40, v44
    v_add_u32 v40, 0x200, v40
    v_bfi_b32 v40, v93, v11, v40
    s_nop 1
    v_mov_b32_dpp v41, v40 quad_perm:[1,1,1,1] row_mask:0xf bank_mask:0xf
    v_mov_b32_dpp v42, v40 quad_perm:[2,2,2,2] row_mask:0xf bank_mask:0xf
    v_mov_b32_dpp v43, v40 quad_perm:[3,3,3,3] row_mask:0xf bank_mask:0xf
    s_mov_b64 exec, s[68:69]
    buffer_store_dwordx4 v[40:43], v10, s[52:55], s11 offen offset:256 sc1
    s_mov_b64 exec, -1
    s_cmp_ge_u32 s2, 80
    s_cbranch_scc1 L_hend
    buffer_load_dwordx4 v[32:35], v87, s[52:55], s15 offen sc1
    buffer_load_dwordx4 v[36:39], v87, s[52:55], s14 offen sc1
    s_sleep 9
    buffer_load_dwordx4 v[40:43], v87, s[52:55], s15 offen sc1
    buffer_load_dwordx4 v[44:47], v87, s[52:55], s14 offen sc1
    s_sleep 9
    buffer_load_dwordx4 v[48:51], v87, s[52:55], s15 offen sc1
    buffer_load_dwordx4 v[52:55], v87, s[52:55], s14 offen sc1
L_yp:
    s_waitcnt vmcnt(4)
    v_xor_b32 v20, s64, v32
    v_xor_b32 v21, s65, v33
    v_or_b32 v20, v20, v21
    v_xor_b32 v21, s66, v34
    v_xor_b32 v22, s67, v35
    v_or3_b32 v20, v20, v21, v22
    v_xor_b32 v21, s64, v36
    v_xor_b32 v22, s65, v37
    v_or3_b32 v20, v20, v21, v22
    v_xor_b32 v21, s66, v38
    v_xor_b32 v22, s67, v39
    v_or3_b32 v20, v20, v21, v22
    v_and_b32 v20, 0x3ff, v20
    v_cmp_ne_u32 vcc, 0, v20
    s_andn2_b64 exec, exec, vcc
    v_add_f32 v12, v32, v36
    v_add_f32 v13, v33, v37
    v_add_f32 v14, v34, v38
    v_add_f32 v15, v35, v39
    s_mov_b64 exec, vcc
    s_cbranch_execz L_ypd
    buffer_load_dwordx4 v[32:35], v87, s[52:55], s15 offen sc1
    buffer_load_dwordx4 v[36:39], v87, s[52:55], s14 offen sc1
    s_waitcnt vmcnt(4)
    v_xor_b32 v20, s64, v40
    v_xor_b32 v21, s65, v41
    v_or_b32 v20, v20, v21
    v_xor_b32 v21, s66, v42
    v_xor_b32 v22, s67, v43
    v_or3_b32 v20, v20, v21, v22
    v_xor_b32 v21, s64, v44
    v_xor_b32 v22, s65, v45
    v_or3_b32 v20, v20, v21, v22
    v_xor_b32 v21, s66, v46
    v_xor_b32 v22, s67, v47
    v_or3_b32 v20, v20, v21, v22
    v_and_b32 v20, 0x3ff, v20
    v_cmp_ne_u32 vcc, 0, v20
    s_andn2_b64 exec, exec, vcc
    v_add_f32 v12, v40, v44
    v_add_f32 v13, v41, v45
    v_add_f32 v14, v42, v46
    v_add_f32 v15, v43, v47
    s_mov_b64 exec, vcc
    s_cbranch_execz L_ypd
    buffer_load_dwordx4 v[40:43], v87, s[52:55], s15 offen sc1
    buffer_load_dwordx4 v[44:47], v87, s[52:55], s14 offen sc1
    s_waitcnt vmcnt(4)
    v_xor_b32 v20, s64, v48
    v_xor_b32 v21, s65, v49
    v_or_b32 v20, v20, v21
    v_xor_b32 v21, s66, v50
    v_xor_b32 v22, s67, v51
    v_or3_b32 v20, v20, v21, v22
    v_xor_b32 v21, s64, v52
    v_xor_b32 v22, s65, v53
    v_or3_b32 v20, v20, v21, v22
    v_xor_b32 v21, s66, v54
    v_xor_b32 v22, s67, v55
    v_or3_b32 v20, v20, v21, v22
    v_and_b32 v20, 0x3ff, v20
    v_cmp_ne_u32 vcc, 0, v20
    s_andn2_b64 exec, exec, vcc
    v_add_f32 v12, v48, v52
    v_add_f32 v13, v49, v53
    v_add_f32 v14, v50, v54
    v_add_f32 v15, v51, v55
    s_mov_b64 exec, vcc
    s_cbranch_execz L_ypd
    buffer_load_dwordx4 v[48:51], v87, s[52:55], s15 offen sc1
    buffer_load_dwordx4 v[52:55], v87, s[52:55], s14 offen sc1
    s_add_u32 s72, s72, 1
    s_cmp_gt_u32 s72, 400000
    s_cbranch_scc1 L_ypd
    s_branch L_yp
L_ypd:
    s_mov_b64 exec, -1
    s_nop 1
    v_permlane32_swap_b32 v12, v13
    v_permlane32_swap_b32 v14, v15
    s_nop 1
    v_add_f32 v12, v12, v13
    v_add_f32 v14, v14, v15
    s_nop 1
    v_permlane16_swap_b32 v12, v14
    s_nop 1
    v_add_f32 v12, v12, v14
    s_nop 1
    v_add_f32_dpp v12, v12, v12 row_ror:8 row_mask:0xf bank_mask:0xf
    ds_write_b32 v86, v12 offset:11008
    v_lshlrev_b32 v12, 2, v0
    s_waitcnt lgkmcnt(0)
    s_barrier
    s_cmp_lg_u32 s3, 3
    s_cbranch_scc1 L_hend
    s_mov_b32 exec_hi, 0
    ds_read_b32 v24, v12 offset:11008
    ds_read_b32 v25, v12 offset:11136
    ds_read_b32 v26, v12 offset:11264
    ds_read_b32 v27, v12 offset:11392
    s_mov_b32 s60, s36
    s_mov_b32 s61, s37
    s_mov_b32 s62, 0x1400
    s_mov_b32 s63, 0x00020000
    s_and_b32 s5, s2, 3
    s_mul_i32 s12, s5, 1280
    s_lshr_b32 s13, s2, 2
    s_lshl_b32 s13, s13, 6
    s_add_u32 s12, s12, s13
    v_lshlrev_b32 v12, 1, v0
    s_waitcnt lgkmcnt(0)
    v_add_f32 v24, v24, v25
    v_add_f32 v26, v26, v27
    v_add_f32 v24, v24, v26
    v_cvt_pk_bf16_f32 v24, v24, v24
    v_lshlrev_b32 v24, 16, v24
    v_mul_f32 v24, v91, v24
    v_cvt_pk_bf16_f32 v24, v24, v24
    v_lshlrev_b32 v24, 16, v24
    v_add_f32 v24, v24, v92
    v_cvt_pk_bf16_f32 v24, v24, v24
    buffer_store_short v24, v12, s[60:63], s12 offen
L_hend:
L_end:
    s_endpgm
L_code_end:
.section .rodata,"a"
.p2align 6
.amdhsa_kernel gated_mix__mha_block_cached__glu_gated_bilinear__decode_kernel
  .amdhsa_next_free_vgpr 256
  .amdhsa_next_free_sgpr 80
  .amdhsa_accum_offset 256
  .amdhsa_group_segment_fixed_size 0
  .amdhsa_kernarg_size 104
  .amdhsa_user_sgpr_count 2
  .amdhsa_user_sgpr_kernarg_segment_ptr 1
  .amdhsa_system_sgpr_workgroup_id_x 1
  .amdhsa_float_denorm_mode_32 3
.end_amdhsa_kernel
```
